```python
import torch

def _softmax(x, axis=-1):
    return torch.softmax(x, dim=axis)

def _gelu(x):
    return torch.nn.functional.gelu(x, approximate='tanh')

def _silu(x):
    return torch.nn.functional.silu(x)

def _sigmoid(x):
    return torch.sigmoid(x)

def _layernorm(x, axis=-1, eps=1e-05):
    m = x.mean(dim=axis, keepdim=True)
    v = x.var(dim=axis, keepdim=True, unbiased=False)
    return (x - m) / torch.sqrt(v + eps)

def _scatter_add(tgt, idx, src, axis=0):
    return tgt.clone().index_add_(axis, idx, src)

def _segment_sum(src, seg, n):
    out = torch.zeros((n,) + src.shape[1:], dtype=src.dtype)
    return out.index_add_(0, seg, src)

def _pad(x, pw):
    flat = tuple((v for pair in reversed(pw) for v in pair))
    return torch.nn.functional.pad(x, flat)
kernel_name = 'adaLN_cond__sliding_block_cached__geglu_ffn__decode'

def setup_inputs():

    _w = lambda a: (lambda t: t.to(torch.bfloat16) if t.is_floating_point() else t)(torch.as_tensor(a))

    def _A_setup():
        B, Sq, D = (1, 1, 512)
        Hq, Hkv, Sk, Dh = (32, 8, 65536, 128)
        assert Hq % Hkv == 0, (Hq, Hkv)
        return {'x': _w((lambda *s: torch.randn(*s, dtype=torch.bfloat16) * 0.1)(B, Sq, D)), 'k_cache': _w((lambda *s: torch.randn(*s, dtype=torch.bfloat16) * 0.8)(B, Hkv, Sk, Dh)), 'v_cache': _w((lambda *s: torch.randn(*s, dtype=torch.bfloat16) * 1.6)(B, Hkv, Sk, Dh)), 'wq': _w((lambda *s: torch.randn(*s, dtype=torch.bfloat16) * 0.8)(D, Hq * Dh) * D ** (-0.5)), 'wo': _w((lambda *s: torch.randn(*s, dtype=torch.bfloat16) * 1.6)(Hq * Dh, D) * (Hq * Dh) ** (-0.5))}
    _A_in = _A_setup()

    def _B_setup():
        B, S, D, F = (1, 1, 512, 1792)
        return {'x': _w((lambda *s: torch.randn(*s, dtype=torch.bfloat16) * 0.1)(B, S, D)), 'w_gate': _w((lambda *s: torch.randn(*s, dtype=torch.bfloat16) * 0.2)(D, F)), 'w_up': _w((lambda *s: torch.randn(*s, dtype=torch.bfloat16) * 0.2)(D, F)), 'w_down': _w((lambda *s: torch.randn(*s, dtype=torch.bfloat16) * 0.2)(F, D))}
    _B_in = _B_setup()
    return {'A_x': _A_in['x'], 'A_k_cache': _A_in['k_cache'], 'A_v_cache': _A_in['v_cache'], 'A_wq': _A_in['wq'], 'A_wo': _A_in['wo'], 'B_x': _B_in['x'], 'B_w_gate': _B_in['w_gate'], 'B_w_up': _B_in['w_up'], 'B_w_down': _B_in['w_down'], 'c': _w((lambda *s: torch.randn(*s, dtype=torch.bfloat16) * 0.4)(1, 512) * 8.0), 'w_mod': _w((lambda *s: torch.randn(*s, dtype=torch.bfloat16) * 0.4)(512, 6 * 512) * 512 ** (-0.5) * 8.0)}

def reference(A_x, A_k_cache, A_v_cache, A_wq, A_wo, B_x, B_w_gate, B_w_up, B_w_down, c, w_mod):

    def _A_ref(x, k_cache, v_cache, wq, wo):
        B, Sq, D = x.shape
        Hq, Dh = (32, 128)
        Hkv, Sk = (k_cache.shape[1], k_cache.shape[2])
        W = min(4096, max(256, Sk // 4))
        rep = Hq // Hkv
        q = (lambda x, *d: x.permute(*d))((x @ wq).reshape(B, Sq, Hq, Dh), 0, 2, 1, 3)
        k = (lambda x, n, axis: torch.repeat_interleave(x, n, dim=axis))(k_cache[:, :, Sk - W:, :], rep, axis=1)
        v = (lambda x, n, axis: torch.repeat_interleave(x, n, dim=axis))(v_cache[:, :, Sk - W:, :], rep, axis=1)
        scores = torch.einsum('bhqd,bhkd->bhqk', q, k) * Dh ** (-0.5)
        p = _softmax(scores, axis=-1)
        o = torch.einsum('bhqk,bhkd->bhqd', p, v)
        return (lambda x, *d: x.permute(*d))(o, 0, 2, 1, 3).reshape(B, Sq, Hq * Dh) @ wo

    def _B_ref(x, w_gate, w_up, w_down):
        return _gelu(x @ w_gate) * (x @ w_up) @ w_down
    x = A_x
    mod = (_silu(c) @ w_mod).reshape(c.shape[0], 6, 1, -1)
    sa, ca, ga, sb, cb, gb = (mod[:, 0].clone(), mod[:, 1].clone(), mod[:, 2].clone(), mod[:, 3].clone(), mod[:, 4].clone(), mod[:, 5].clone())
    h = _layernorm(x, axis=-1) * (1 + ca) + sa
    x = x + ga * _A_ref(h, A_k_cache, A_v_cache, A_wq, A_wo)
    h = _layernorm(x, axis=-1) * (1 + cb) + sb
    x = x + gb * _B_ref(h, B_w_gate, B_w_up, B_w_down)
    return x
```

```asm
; @launch grid=(256,1,1) block=(512,1,1) lds=79872
.amdgcn_target "amdgcn-amd-amdhsa--gfx950"
.text
.globl adaLN_cond__sliding_block_cached__geglu_ffn__decode_kernel
.p2align 8
.type adaLN_cond__sliding_block_cached__geglu_ffn__decode_kernel,@function
adaLN_cond__sliding_block_cached__geglu_ffn__decode_kernel:
    s_load_dwordx8 s[20:27], s[0:1], 64
    s_load_dwordx4 s[28:31], s[0:1], 96
    s_load_dwordx16 s[4:19], s[0:1], 0
    s_getpc_b64 s[36:37]
L_pc:
    s_cmp_ge_u32 s2, 256
    s_cbranch_scc1 L_exit
    s_lshr_b32 s1, s2, 3
    s_and_b32 s0, s2, 7
    v_lshrrev_b32 v1, 6, v0
    v_and_b32 v0, 63, v0
    v_readfirstlane_b32 s3, v1
    s_and_b32 s38, s1, 15
    s_lshl_b32 s38, s38, 10
    v_lshl_add_u32 v2, v0, 7, s38
    s_mov_b32 s50, 4194304
    s_mov_b32 s51, 0x20000
    s_mov_b32 s55, 0x20000
    s_cmp_lt_u32 s3, 4
    s_cbranch_scc1 L_nopf
    s_cmp_lg_u32 s3, 4
    s_cbranch_scc1 L_nocp
    v_min_u32 v2, L_codeend-L_pc-1028, v2
    s_mov_b64 exec, 0xff
    global_load_dword v250, v2, s[36:37] offset:1024
    s_mov_b64 exec, -1
L_nocp:
    s_cmp_lt_u32 s1, 16
    s_cbranch_scc1 L_nopf
    s_cmp_gt_u32 s3, 5
    s_cbranch_scc1 L_hend
    s_cmp_lt_u32 s1, 24
    s_cbranch_scc1 L_probe
    s_cmp_lt_u32 s1, 28
    s_cbranch_scc1 L_hend
    s_setprio 3
    v_lshrrev_b32 v7, 2, v0
    v_and_b32 v9, 3, v0
    v_lshl_add_u32 v7, v7, 3, v9
    v_mul_u32_u24 v7, 6144, v7
    s_and_b32 s44, s1, 2
    s_and_b32 s45, s3, 1
    s_add_u32 s44, s44, s45
    s_lshl_b32 s44, s44, 7
    s_add_u32 s44, s44, 4
    s_mul_i32 s42, s44, 6144
    s_lshl_b32 s44, s0, 1
    s_and_b32 s45, s1, 1
    s_add_u32 s44, s44, s45
    s_lshl_b32 s44, s44, 7
    s_add_u32 s42, s42, s44
    s_mov_b32 s54, 3145728
    s_waitcnt lgkmcnt(0)
    s_mov_b64 s[52:53], s[24:25]
    buffer_load_dword v41, v7, s[52:55], s42 offen
    s_branch L_helper_g
L_hend:
    s_endpgm
L_nopf:
    v_lshrrev_b32 v2, 4, v0
    v_and_b32 v3, 15, v0
    s_mov_b32 s33, 0x05040100
    s_mov_b32 s34, 0x07060302
    v_lshlrev_b32 v8, 4, v0
    s_mov_b32 s99, 0x20000
    s_mov_b32 s95, 0x20000
    s_cmp_lt_u32 s1, 16
    s_cbranch_scc1 L_att
    v_lshrrev_b32 v4, 3, v3
    v_and_b32 v5, 7, v3
    v_lshl_add_u32 v4, v4, 2, v2
    s_lshl_b32 s39, s3, 8
    s_mov_b32 s94, 1024
    s_cmp_lt_u32 s1, 24
    s_cbranch_scc1 L_b
    v_mul_u32_u24 v6, 49152, v4
    v_lshl_add_u32 v6, v5, 4, v6
    v_lshl_add_u32 v7, v4, 4, s39
    s_mul_i32 s37, s3, 786432
    s_movk_i32 s46, 6144
    s_mov_b32 s47, 350208
    s_mov_b32 s54, 3145728
    s_cmp_ge_u32 s1, 28
    s_cbranch_scc1 L_g_rest
    s_lshl_b32 s45, s0, 1
    s_and_b32 s44, s1, 1
    s_add_u32 s45, s45, s44
    s_bfe_u32 s44, s1, 0x10001
    s_lshl_b32 s38, s44, 2
    s_add_u32 s38, s38, s3
    s_mul_i32 s37, s38, 393216
    s_lshl_b32 s38, s38, 7
    v_lshl_add_u32 v7, v4, 4, s38
    s_lshl_b32 s38, s45, 7
    s_add_u32 s37, s37, s38
    s_waitcnt lgkmcnt(0)
    s_mov_b64 s[52:53], s[24:25]
    s_mov_b64 s[92:93], s[22:23]
    buffer_load_dwordx4 v[240:243], v7, s[92:95], 0 offen
    buffer_load_dwordx4 v[16:19], v6, s[52:55], s37 offen nt
    s_add_u32 s37, s37, s46
    buffer_load_dwordx4 v[20:23], v6, s[52:55], s37 offen nt
    s_add_u32 s37, s37, s46
    buffer_load_dwordx4 v[24:27], v6, s[52:55], s37 offen nt
    s_add_u32 s37, s37, s46
    buffer_load_dwordx4 v[28:31], v6, s[52:55], s37 offen nt
    s_add_u32 s37, s37, s46
    buffer_load_dwordx4 v[32:35], v6, s[52:55], s37 offen nt
    s_add_u32 s37, s37, s46
    buffer_load_dwordx4 v[36:39], v6, s[52:55], s37 offen nt
    s_add_u32 s37, s37, s46
    buffer_load_dwordx4 v[40:43], v6, s[52:55], s37 offen nt
    s_add_u32 s37, s37, s46
    buffer_load_dwordx4 v[44:47], v6, s[52:55], s37 offen nt
    s_add_u32 s48, s30, 532676608
    s_addc_u32 s49, s31, 0
    s_load_dwordx4 s[28:31], s[48:49], 0
    s_branch L_a2
L_b:
    s_lshl_b32 s2, s0, 3
    s_add_u32 s2, s2, s1
    s_sub_u32 s2, s2, 16
    v_lshlrev_b32 v6, 16, v4
    v_lshl_add_u32 v6, v5, 4, v6
    s_lshl_b32 s36, s3, 20
    s_lshl_b32 s37, s2, 7
    s_add_u32 s37, s36, s37
    s_movk_i32 s46, 8192
    s_mov_b32 s47, 466944
    s_mov_b32 s54, 4194304
    v_lshl_add_u32 v7, v0, 2, s39
    s_waitcnt lgkmcnt(0)
    s_mov_b64 s[52:53], s[10:11]
    s_mov_b64 s[92:93], s[4:5]
    s_add_u32 s48, s30, 532676608
    s_addc_u32 s49, s31, 0
    s_load_dwordx4 s[28:31], s[48:49], 0
    buffer_load_dwordx4 v[216:219], v8, s[92:95], 0 offen
    buffer_load_dword v220, v7, s[92:95], 0 offen
    buffer_load_dwordx4 v[16:19], v6, s[52:55], s37 offen nt
    s_add_u32 s37, s37, s46
    buffer_load_dwordx4 v[20:23], v6, s[52:55], s37 offen nt
    s_add_u32 s37, s37, s46
    buffer_load_dwordx4 v[24:27], v6, s[52:55], s37 offen nt
    s_add_u32 s37, s37, s46
    buffer_load_dwordx4 v[28:31], v6, s[52:55], s37 offen nt
    s_add_u32 s37, s37, s46
    buffer_load_dwordx4 v[32:35], v6, s[52:55], s37 offen nt
    s_add_u32 s37, s37, s46
    buffer_load_dwordx4 v[36:39], v6, s[52:55], s37 offen nt
    s_add_u32 s37, s37, s46
    buffer_load_dwordx4 v[40:43], v6, s[52:55], s37 offen nt
    s_add_u32 s37, s37, s46
    buffer_load_dwordx4 v[44:47], v6, s[52:55], s37 offen nt
    s_add_u32 s37, s37, s47
    buffer_load_dwordx4 v[48:51], v6, s[52:55], s37 offen nt
    s_add_u32 s37, s37, s46
    buffer_load_dwordx4 v[52:55], v6, s[52:55], s37 offen nt
    s_add_u32 s37, s37, s46
    buffer_load_dwordx4 v[56:59], v6, s[52:55], s37 offen nt
    s_add_u32 s37, s37, s46
    buffer_load_dwordx4 v[60:63], v6, s[52:55], s37 offen nt
    s_add_u32 s37, s37, s46
    buffer_load_dwordx4 v[64:67], v6, s[52:55], s37 offen nt
    s_add_u32 s37, s37, s46
    buffer_load_dwordx4 v[68:71], v6, s[52:55], s37 offen nt
    s_add_u32 s37, s37, s46
    buffer_load_dwordx4 v[72:75], v6, s[52:55], s37 offen nt
    s_add_u32 s37, s37, s46
    buffer_load_dwordx4 v[76:79], v6, s[52:55], s37 offen nt
    s_branch L_b2
L_att:
    v_mov_b32 v11, 0x10600
    v_mov_b32 v12, 0
    ds_write_b32 v11, v12
    s_and_b32 s39, s3, 3
    s_lshl_b32 s36, s0, 24
    s_lshl_b32 s37, s1, 12
    s_lshl_b32 s38, s39, 10
    s_add_u32 s36, s36, s37
    s_add_u32 s36, s36, s38
    s_add_u32 s36, s36, 15728640
    s_mov_b32 s54, 0x8000000
    s_mov_b32 s37, s36
    s_cmp_ge_u32 s3, 4
    s_cbranch_scc1 L_attv
    s_lshl_b32 s38, s3, 14
    v_lshlrev_b32 v5, 2, v2
    v_xor_b32 v5, v5, v3
    v_lshlrev_b32 v5, 4, v5
    v_lshl_add_u32 v4, v2, 8, v5
    v_xor_b32 v5, 16, v4
    v_xor_b32 v6, 32, v4
    v_xor_b32 v7, 48, v4
    s_mov_b32 m0, s38
    s_movk_i32 s47, 1024
    v_and_b32 v9, 7, v0
    v_lshlrev_b32 v9, 7, v9
    v_bfe_u32 v10, v0, 3, 2
    v_lshl_add_u32 v9, v10, 13, v9
    v_add_u32 v9, 524288, v9
    v_lshlrev_b32 v10, 13, v3
    v_add_u32 v10, 384, v10
    s_nop 1
    v_mov_b32_dpp v9, v10 quad_perm:[0,1,2,3] row_mask:0x4 bank_mask:0xf
    s_lshr_b32 s40, s1, 2
    s_lshl_b32 s40, s40, 20
    s_and_b32 s41, s1, 3
    s_lshl_b32 s41, s41, 2
    s_add_u32 s41, s41, s3
    s_lshl_b32 s41, s41, 15
    s_add_u32 s40, s40, s41
    s_lshl_b32 s41, s0, 10
    s_add_u32 s40, s40, s41
    s_mov_b32 s98, 4194304
    s_waitcnt lgkmcnt(0)
    s_mov_b64 s[52:53], s[6:7]
    s_mov_b64 s[96:97], s[10:11]
    s_add_u32 s48, s30, 532676608
    s_addc_u32 s49, s31, 0
    s_load_dwordx4 s[28:31], s[48:49], 0
    s_waitcnt lgkmcnt(0)
    s_setprio 2
    s_mov_b32 exec_hi, 15
    buffer_load_dword v251, v9, s[96:99], s40 offen
    s_mov_b64 exec, -1
    buffer_load_dwordx4 v4, s[52:55], s37 offen nt lds
    s_add_u32 m0, m0, s47
    s_xor_b32 s37, s36, 0x11000
    buffer_load_dwordx4 v5, s[52:55], s37 offen nt lds
    s_add_u32 m0, m0, s47
    s_xor_b32 s37, s36, 0x22000
    buffer_load_dwordx4 v6, s[52:55], s37 offen nt lds
    s_add_u32 m0, m0, s47
    s_xor_b32 s37, s36, 0x33000
    buffer_load_dwordx4 v7, s[52:55], s37 offen nt lds
    s_add_u32 m0, m0, s47
    s_xor_b32 s37, s36, 0x44000
    buffer_load_dwordx4 v4, s[52:55], s37 offen nt lds
    s_add_u32 m0, m0, s47
    s_xor_b32 s37, s36, 0x55000
    buffer_load_dwordx4 v5, s[52:55], s37 offen nt lds
    s_add_u32 m0, m0, s47
    s_xor_b32 s37, s36, 0x66000
    buffer_load_dwordx4 v6, s[52:55], s37 offen nt lds
    s_add_u32 m0, m0, s47
    s_xor_b32 s37, s36, 0x77000
    s_barrier
    buffer_load_dwordx4 v7, s[52:55], s37 offen nt lds
    s_add_u32 m0, m0, s47
    s_xor_b32 s37, s36, 0x88000
    buffer_load_dwordx4 v4, s[52:55], s37 offen nt lds
    s_add_u32 m0, m0, s47
    s_xor_b32 s37, s36, 0x99000
    buffer_load_dwordx4 v5, s[52:55], s37 offen nt lds
    s_add_u32 m0, m0, s47
    s_xor_b32 s37, s36, 0xaa000
    buffer_load_dwordx4 v6, s[52:55], s37 offen nt lds
    s_add_u32 m0, m0, s47
    s_xor_b32 s37, s36, 0xbb000
    buffer_load_dwordx4 v7, s[52:55], s37 offen nt lds
    s_add_u32 m0, m0, s47
    s_xor_b32 s37, s36, 0xcc000
    buffer_load_dwordx4 v4, s[52:55], s37 offen nt lds
    s_add_u32 m0, m0, s47
    s_xor_b32 s37, s36, 0xdd000
    buffer_load_dwordx4 v5, s[52:55], s37 offen nt lds
    s_add_u32 m0, m0, s47
    s_xor_b32 s37, s36, 0xee000
    buffer_load_dwordx4 v6, s[52:55], s37 offen nt lds
    s_add_u32 m0, m0, s47
    s_xor_b32 s37, s36, 0xff000
    buffer_load_dwordx4 v7, s[52:55], s37 offen nt lds
    s_branch L_attk2
L_attv:
    s_waitcnt lgkmcnt(0)
    s_mov_b64 s[52:53], s[8:9]
    s_add_u32 s48, s30, 532676608
    s_addc_u32 s49, s31, 0
    s_load_dwordx4 s[28:31], s[48:49], 0
    s_barrier
    buffer_load_dwordx4 v[16:19], v8, s[52:55], s37 offen nt
    s_xor_b32 s37, s36, 0x11000
    buffer_load_dwordx4 v[20:23], v8, s[52:55], s37 offen nt
    s_xor_b32 s37, s36, 0x22000
    buffer_load_dwordx4 v[24:27], v8, s[52:55], s37 offen nt
    s_xor_b32 s37, s36, 0x33000
    buffer_load_dwordx4 v[28:31], v8, s[52:55], s37 offen nt
    s_xor_b32 s37, s36, 0x44000
    buffer_load_dwordx4 v[32:35], v8, s[52:55], s37 offen nt
    s_xor_b32 s37, s36, 0x55000
    buffer_load_dwordx4 v[36:39], v8, s[52:55], s37 offen nt
    s_xor_b32 s37, s36, 0x66000
    buffer_load_dwordx4 v[40:43], v8, s[52:55], s37 offen nt
    s_xor_b32 s37, s36, 0x77000
    buffer_load_dwordx4 v[44:47], v8, s[52:55], s37 offen nt
    s_xor_b32 s37, s36, 0x88000
    buffer_load_dwordx4 v[48:51], v8, s[52:55], s37 offen nt
    s_xor_b32 s37, s36, 0x99000
    s_waitcnt vmcnt(8)
    buffer_load_dwordx4 v[52:55], v8, s[52:55], s37 offen nt
    s_xor_b32 s37, s36, 0xaa000
    s_waitcnt vmcnt(8)
    buffer_load_dwordx4 v[56:59], v8, s[52:55], s37 offen nt
    s_xor_b32 s37, s36, 0xbb000
    s_waitcnt vmcnt(8)
    buffer_load_dwordx4 v[60:63], v8, s[52:55], s37 offen nt
    s_xor_b32 s37, s36, 0xcc000
L_vg:
    ds_read_b32 v14, v11
    s_waitcnt lgkmcnt(0)
    v_cmp_eq_u32 vcc, 0, v14
    s_cbranch_vccnz L_vg
    buffer_load_dwordx4 v[64:67], v8, s[52:55], s37 offen nt
    s_xor_b32 s37, s36, 0xdd000
    buffer_load_dwordx4 v[68:71], v8, s[52:55], s37 offen nt
    s_xor_b32 s37, s36, 0xee000
    buffer_load_dwordx4 v[72:75], v8, s[52:55], s37 offen nt
    s_xor_b32 s37, s36, 0xff000
    buffer_load_dwordx4 v[76:79], v8, s[52:55], s37 offen nt
    s_branch L_attv2
L_helper_g:
    v_lshlrev_b32 v6, 7, v0
    s_lshl_b32 s40, s0, 15
    s_and_b32 s41, s1, 3
    s_lshl_b32 s41, s41, 13
    s_add_u32 s40, s40, s41
    s_add_u32 s40, s40, 1703936
    s_lshl_b32 s41, s0, 11
    s_add_u32 s41, s41, 65536
    s_cmp_eq_u32 s3, 4
    s_cselect_b32 s40, s40, s41
    s_cselect_b64 exec, -1, 0xffff
    s_add_u32 s48, s30, 532676608
    s_addc_u32 s49, s31, 0
    buffer_load_dword v45, v6, s[48:51], s40 offen sc1
    s_endpgm
L_probe:
    s_cmp_eq_u32 s3, 4
    s_cbranch_scc1 L_hend
    s_lshl_b32 s36, s0, 15
    s_lshl_b32 s37, s1, 7
    s_add_u32 s36, s36, s37
    s_add_u32 s36, s36, 1177600
    s_mov_b32 s40, -1
    s_mov_b32 s41, -1
    s_mov_b32 s42, 0
    v_mov_b32 v6, 12288
    s_waitcnt lgkmcnt(0)
    s_add_u32 s48, s30, 532676608
    s_addc_u32 s49, s31, 0
    s_load_dwordx4 s[28:31], s[48:49], 0
    s_add_u32 s38, s48, s36
    s_addc_u32 s39, s49, 0
    s_load_dword s43, s[38:39], 0 glc
    s_load_dword s43, s[38:39], 8192 glc
    s_waitcnt lgkmcnt(0)
    s_mul_i32 s32, s28, 0x9E3779B5
    s_add_u32 s32, s32, 0x7F4A7C15
    s_movk_i32 s101, 0xff
L_tg_1:
    s_xor_b32 s100, s32, s28
    s_and_b32 s100, s100, s101
    s_cbranch_scc0 L_tg_1_bump
    s_xor_b32 s100, s32, s29
    s_and_b32 s100, s100, s101
    s_cbranch_scc0 L_tg_1_bump
    s_xor_b32 s100, s32, s30
    s_and_b32 s100, s100, s101
    s_cbranch_scc0 L_tg_1_bump
    s_xor_b32 s100, s32, s31
    s_and_b32 s100, s100, s101
    s_cbranch_scc0 L_tg_1_bump
    s_and_b32 s100, s32, s101
    v_mov_b32 v5, s32
L_pr:
    s_memtime s[44:45]
    s_waitcnt lgkmcnt(0)
    s_load_dword s43, s[38:39], 0 glc
    s_waitcnt lgkmcnt(0)
    s_memtime s[46:47]
    s_waitcnt lgkmcnt(0)
    s_sub_u32 s46, s46, s44
    s_min_u32 s40, s40, s46
    s_memtime s[44:45]
    s_waitcnt lgkmcnt(0)
    s_load_dword s43, s[38:39], 8192 glc
    s_waitcnt lgkmcnt(0)
    s_memtime s[46:47]
    s_waitcnt lgkmcnt(0)
    s_sub_u32 s46, s46, s44
    s_min_u32 s41, s41, s46
    s_cmp_le_u32 s40, s41
    s_cselect_b32 s36, 0, 8192
    v_mov_b32 v4, s36
    ds_write_b64 v6, v[4:5]
    s_add_u32 s42, s42, 1
    s_cmp_lt_u32 s42, 2
    s_cbranch_scc1 L_pr
    s_endpgm
    .p2align 6
L_a2:
    s_mov_b32 s56, 0xff
    s_mov_b32 s57, 0xff00
    s_lshl_b32 s40, s45, 9
    s_lshl_b32 s42, s44, 14
    s_add_u32 s40, s40, s42
    s_lshl_b32 s42, s3, 16
    s_add_u32 s40, s40, s42
    s_add_u32 s40, s40, 1703936
    s_add_u32 s42, s40, 8192
    v_and_b32 v12, 31, v0
    v_lshlrev_b32 v13, 4, v12
    v_lshrrev_b32 v11, 5, v0
    v_lshl_add_u32 v13, v11, 15, v13
    v_lshlrev_b32 v12, 3, v12
    s_lshl_b32 s36, s3, 9
    v_lshl_add_u32 v11, v3, 5, s36
    s_mov_b32 s59, 0xbfb8aa3b
    s_waitcnt lgkmcnt(0)
    s_mul_i32 s32, s28, 0x9E3779B5
    s_add_u32 s32, s32, 0x7F4A7C15
    s_movk_i32 s101, 0xff
L_tg_2:
    s_xor_b32 s100, s32, s28
    s_and_b32 s100, s100, s101
    s_cbranch_scc0 L_tg_2_bump
    s_xor_b32 s100, s32, s29
    s_and_b32 s100, s100, s101
    s_cbranch_scc0 L_tg_2_bump
    s_xor_b32 s100, s32, s30
    s_and_b32 s100, s100, s101
    s_cbranch_scc0 L_tg_2_bump
    s_xor_b32 s100, s32, s31
    s_and_b32 s100, s100, s101
    s_cbranch_scc0 L_tg_2_bump
    s_and_b32 s100, s32, s101
    v_mov_b32 v50, 0
    v_mov_b32 v51, s32
    s_waitcnt vmcnt(8)
    v_lshlrev_b32 v112, 16, v240
    v_and_b32 v113, 0xffff0000, v240
    v_lshlrev_b32 v116, 16, v241
    v_and_b32 v117, 0xffff0000, v241
    v_lshlrev_b32 v120, 16, v242
    v_and_b32 v121, 0xffff0000, v242
    v_lshlrev_b32 v124, 16, v243
    v_and_b32 v125, 0xffff0000, v243
    v_mul_f32 v114, s59, v112
    v_mul_f32 v115, s59, v113
    v_mul_f32 v118, s59, v116
    v_mul_f32 v119, s59, v117
    v_mul_f32 v122, s59, v120
    v_mul_f32 v123, s59, v121
    v_mul_f32 v126, s59, v124
    v_mul_f32 v127, s59, v125
    v_exp_f32 v114, v114
    v_exp_f32 v115, v115
    v_exp_f32 v118, v118
    v_exp_f32 v119, v119
    v_exp_f32 v122, v122
    v_exp_f32 v123, v123
    v_exp_f32 v126, v126
    v_exp_f32 v127, v127
    v_add_f32 v114, 1.0, v114
    v_add_f32 v115, 1.0, v115
    v_add_f32 v118, 1.0, v118
    v_add_f32 v119, 1.0, v119
    v_add_f32 v122, 1.0, v122
    v_add_f32 v123, 1.0, v123
    v_add_f32 v126, 1.0, v126
    v_add_f32 v127, 1.0, v127
    v_rcp_f32 v114, v114
    v_rcp_f32 v115, v115
    v_rcp_f32 v118, v118
    v_rcp_f32 v119, v119
    v_rcp_f32 v122, v122
    v_rcp_f32 v123, v123
    v_rcp_f32 v126, v126
    v_rcp_f32 v127, v127
    v_mul_f32 v112, v112, v114
    v_mul_f32 v113, v113, v115
    v_mul_f32 v116, v116, v118
    v_mul_f32 v117, v117, v119
    v_mul_f32 v120, v120, v122
    v_mul_f32 v121, v121, v123
    v_mul_f32 v124, v124, v126
    v_mul_f32 v125, v125, v127
    v_cvt_pk_bf16_f32 v248, v112, v113
    v_cvt_pk_bf16_f32 v249, v116, v117
    v_cvt_pk_bf16_f32 v250, v120, v121
    v_cvt_pk_bf16_f32 v251, v124, v125
    s_waitcnt vmcnt(6)
    v_perm_b32 v80, v20, v16, s33
    v_perm_b32 v84, v20, v16, s34
    v_perm_b32 v88, v21, v17, s33
    v_perm_b32 v92, v21, v17, s34
    v_perm_b32 v96, v22, v18, s33
    v_perm_b32 v100, v22, v18, s34
    v_perm_b32 v104, v23, v19, s33
    v_perm_b32 v108, v23, v19, s34
    s_waitcnt vmcnt(4)
    v_perm_b32 v81, v28, v24, s33
    v_perm_b32 v85, v28, v24, s34
    v_perm_b32 v89, v29, v25, s33
    v_perm_b32 v93, v29, v25, s34
    v_perm_b32 v97, v30, v26, s33
    v_perm_b32 v101, v30, v26, s34
    v_perm_b32 v105, v31, v27, s33
    v_perm_b32 v109, v31, v27, s34
    s_waitcnt vmcnt(2)
    v_perm_b32 v82, v36, v32, s33
    v_perm_b32 v86, v36, v32, s34
    v_perm_b32 v90, v37, v33, s33
    v_perm_b32 v94, v37, v33, s34
    v_perm_b32 v98, v38, v34, s33
    v_perm_b32 v102, v38, v34, s34
    v_perm_b32 v106, v39, v35, s33
    v_perm_b32 v110, v39, v35, s34
    s_waitcnt vmcnt(0)
    v_perm_b32 v83, v44, v40, s33
    v_perm_b32 v87, v44, v40, s34
    v_perm_b32 v91, v45, v41, s33
    v_perm_b32 v95, v45, v41, s34
    v_perm_b32 v99, v46, v42, s33
    v_perm_b32 v103, v46, v42, s34
    v_perm_b32 v107, v47, v43, s33
    v_perm_b32 v111, v47, v43, s34
    v_mfma_f32_16x16x32_bf16 v[112:115], v[248:251], v[80:83], 0
    v_mfma_f32_16x16x32_bf16 v[116:119], v[248:251], v[84:87], 0
    v_mfma_f32_16x16x32_bf16 v[120:123], v[248:251], v[88:91], 0
    v_mfma_f32_16x16x32_bf16 v[124:127], v[248:251], v[92:95], 0
    v_mfma_f32_16x16x32_bf16 v[128:131], v[248:251], v[96:99], 0
    v_mfma_f32_16x16x32_bf16 v[132:135], v[248:251], v[100:103], 0
    v_mfma_f32_16x16x32_bf16 v[136:139], v[248:251], v[104:107], 0
    v_mfma_f32_16x16x32_bf16 v[140:143], v[248:251], v[108:111], 0
    s_mov_b64 exec, s[56:57]
    s_nop 0
    ds_write2_b32 v11, v112, v116 offset0:0 offset1:1
    s_nop 0
    ds_write2_b32 v11, v120, v124 offset0:2 offset1:3
    s_nop 0
    ds_write2_b32 v11, v128, v132 offset0:4 offset1:5
    s_nop 0
    ds_write2_b32 v11, v136, v140 offset0:6 offset1:7
    s_mov_b64 exec, -1
    s_waitcnt lgkmcnt(0)
    s_barrier
    ds_read2_b64 v[52:55], v12 offset0:0 offset1:32
    ds_read2_b64 v[56:59], v12 offset0:64 offset1:96
    ds_read2_b64 v[60:63], v12 offset0:128 offset1:160
    ds_read2_b64 v[64:67], v12 offset0:192 offset1:224
    s_waitcnt lgkmcnt(2)
    v_pk_add_f32 v[52:53], v[52:53], v[54:55]
    v_pk_add_f32 v[56:57], v[56:57], v[58:59]
    s_waitcnt lgkmcnt(0)
    v_pk_add_f32 v[60:61], v[60:61], v[62:63]
    v_pk_add_f32 v[64:65], v[64:65], v[66:67]
    v_pk_add_f32 v[52:53], v[52:53], v[56:57]
    v_pk_add_f32 v[60:61], v[60:61], v[64:65]
    v_pk_add_f32 v[48:49], v[52:53], v[60:61]
    buffer_store_dwordx4 v[48:51], v13, s[48:51], s40 offen sc1
    buffer_store_dwordx4 v[48:51], v13, s[48:51], s42 offen sc1
    s_barrier
    s_mov_b64 s[96:97], s[12:13]
    s_mov_b32 s98, 4194304
    s_and_b32 s40, s1, 3
    s_lshl_b32 s40, s40, 2
    s_add_u32 s40, s40, s3
    s_lshl_b32 s40, s40, 15
    s_lshl_b32 s42, s0, 19
    s_add_u32 s40, s40, s42
    s_add_u32 s40, s40, 384
    v_lshlrev_b32 v13, 10, v0
    s_mov_b32 exec_hi, 0
    buffer_load_dword v246, v13, s[96:99], s40 offen
    s_mov_b64 exec, -1
    s_mov_b32 s41, 0
    s_branch L_g2
    .p2align 6
L_b2:
    s_mov_b64 s[96:97], s[12:13]
    s_mov_b32 s98, 4194304
    v_lshlrev_b32 v1, 13, v4
    v_lshl_add_u32 v1, v5, 4, v1
    s_add_u32 s45, s1, 4
    s_and_b32 s45, s45, 7
    s_lshl_b32 s44, s0, 2
    s_add_u32 s44, s44, s3
    s_lshl_b32 s16, s44, 17
    s_lshl_b32 s17, s45, 7
    s_add_u32 s16, s16, s17
    s_add_u32 s17, s16, 4096
    s_add_u32 s18, s16, 65536
    s_add_u32 s19, s16, 69632
    s_mov_b32 s56, 0xff
    s_mov_b32 s57, 0xff00
    s_waitcnt vmcnt(16)
    v_lshlrev_b32 v224, 16, v216
    v_and_b32 v225, 0xffff0000, v216
    v_lshlrev_b32 v226, 16, v217
    v_and_b32 v227, 0xffff0000, v217
    v_lshlrev_b32 v228, 16, v218
    v_and_b32 v229, 0xffff0000, v218
    v_lshlrev_b32 v230, 16, v219
    v_and_b32 v231, 0xffff0000, v219
    v_add_f32 v232, v224, v225
    v_add_f32 v232, v232, v226
    v_add_f32 v232, v232, v227
    v_add_f32 v232, v232, v228
    v_add_f32 v232, v232, v229
    v_add_f32 v232, v232, v230
    v_add_f32 v232, v232, v231
    v_mov_b32 v233, 0
    s_nop 0
    v_add_f32_dpp v232, v232, v232 row_ror:8 row_mask:0xf bank_mask:0xf
    v_add_f32_dpp v233, v233, v233 row_ror:8 row_mask:0xf bank_mask:0xf
    s_nop 0
    v_add_f32_dpp v232, v232, v232 row_ror:4 row_mask:0xf bank_mask:0xf
    v_add_f32_dpp v233, v233, v233 row_ror:4 row_mask:0xf bank_mask:0xf
    s_nop 0
    v_add_f32_dpp v232, v232, v232 row_ror:2 row_mask:0xf bank_mask:0xf
    v_add_f32_dpp v233, v233, v233 row_ror:2 row_mask:0xf bank_mask:0xf
    s_nop 0
    v_add_f32_dpp v232, v232, v232 row_ror:1 row_mask:0xf bank_mask:0xf
    v_add_f32_dpp v233, v233, v233 row_ror:1 row_mask:0xf bank_mask:0xf
    s_nop 0
    v_add_f32_dpp v232, v232, v232 row_bcast:15 row_mask:0xa bank_mask:0xf
    v_add_f32_dpp v233, v233, v233 row_bcast:15 row_mask:0xa bank_mask:0xf
    s_nop 0
    v_add_f32_dpp v232, v232, v232 row_bcast:31 row_mask:0xc bank_mask:0xf
    v_add_f32_dpp v233, v233, v233 row_bcast:31 row_mask:0xc bank_mask:0xf
    v_readlane_b32 s36, v232, 63
    v_mov_b32 v234, 0x3b000000
    s_nop 0
    v_mul_f32 v235, s36, v234
    v_sub_f32 v224, v224, v235
    v_sub_f32 v225, v225, v235
    v_sub_f32 v226, v226, v235
    v_sub_f32 v227, v227, v235
    v_sub_f32 v228, v228, v235
    v_sub_f32 v229, v229, v235
    v_sub_f32 v230, v230, v235
    v_sub_f32 v231, v231, v235
    v_mul_f32 v232, v224, v224
    v_fmac_f32 v232, v225, v225
    v_fmac_f32 v232, v226, v226
    v_fmac_f32 v232, v227, v227
    v_fmac_f32 v232, v228, v228
    v_fmac_f32 v232, v229, v229
    v_fmac_f32 v232, v230, v230
    v_fmac_f32 v232, v231, v231
    s_nop 1
    v_add_f32_dpp v232, v232, v232 row_ror:8 row_mask:0xf bank_mask:0xf
    v_add_f32_dpp v233, v233, v233 row_ror:8 row_mask:0xf bank_mask:0xf
    s_nop 0
    v_add_f32_dpp v232, v232, v232 row_ror:4 row_mask:0xf bank_mask:0xf
    v_add_f32_dpp v233, v233, v233 row_ror:4 row_mask:0xf bank_mask:0xf
    s_nop 0
    v_add_f32_dpp v232, v232, v232 row_ror:2 row_mask:0xf bank_mask:0xf
    v_add_f32_dpp v233, v233, v233 row_ror:2 row_mask:0xf bank_mask:0xf
    s_nop 0
    v_add_f32_dpp v232, v232, v232 row_ror:1 row_mask:0xf bank_mask:0xf
    v_add_f32_dpp v233, v233, v233 row_ror:1 row_mask:0xf bank_mask:0xf
    s_nop 0
    v_add_f32_dpp v232, v232, v232 row_bcast:15 row_mask:0xa bank_mask:0xf
    v_add_f32_dpp v233, v233, v233 row_bcast:15 row_mask:0xa bank_mask:0xf
    s_nop 0
    v_add_f32_dpp v232, v232, v232 row_bcast:31 row_mask:0xc bank_mask:0xf
    v_add_f32_dpp v233, v233, v233 row_bcast:31 row_mask:0xc bank_mask:0xf
    v_readlane_b32 s36, v232, 63
    s_nop 1
    v_mul_f32 v232, s36, v234
    v_cvt_pk_bf16_f32 v226, v235, v232
    v_and_b32 v232, 0xffff0000, v226
    v_lshlrev_b32 v222, 16, v226
    v_add_f32 v232, 0x3727c5ac, v232
    v_cvt_pk_bf16_f32 v232, 0, v232
    v_sqrt_f32 v232, v232
    s_nop 0
    v_cvt_pk_bf16_f32 v232, 0, v232
    v_rcp_f32 v223, v232
    v_lshlrev_b32 v224, 16, v220
    v_and_b32 v225, 0xffff0000, v220
    v_sub_f32 v224, v224, v222
    v_sub_f32 v225, v225, v222
    v_cvt_pk_bf16_f32 v224, 0, v224
    v_cvt_pk_bf16_f32 v225, 0, v225
    v_mul_f32 v224, v224, v223
    v_mul_f32 v225, v225, v223
    v_cvt_pk_bf16_f32 v224, 0, v224
    v_cvt_pk_bf16_f32 v225, 0, v225
    s_lshl_b32 s40, s3, 10
    s_lshl_b32 s41, s0, 15
    s_add_u32 s40, s40, s41
    s_add_u32 s40, s40, 1703936
    v_mov_b32 v12, 12288
    v_add_u32 v9, 4096, v8
    v_lshl_add_u32 v10, v4, 4, s39
    s_lshl_b32 s36, s3, 9
    v_lshl_add_u32 v11, v3, 5, s36
    s_lshl_b32 s36, s2, 8
    s_add_u32 s36, s36, 65536
    s_add_u32 s38, s36, 2097152
    s_waitcnt lgkmcnt(0)
    s_mul_i32 s32, s28, 0x9E3779B5
    s_add_u32 s32, s32, 0x7F4A7C15
    s_movk_i32 s101, 0xff
L_tg_3:
    s_xor_b32 s100, s32, s28
    s_and_b32 s100, s100, s101
    s_cbranch_scc0 L_tg_3_bump
    s_xor_b32 s100, s32, s29
    s_and_b32 s100, s100, s101
    s_cbranch_scc0 L_tg_3_bump
    s_xor_b32 s100, s32, s30
    s_and_b32 s100, s100, s101
    s_cbranch_scc0 L_tg_3_bump
    s_xor_b32 s100, s32, s31
    s_and_b32 s100, s100, s101
    s_cbranch_scc0 L_tg_3_bump
    s_and_b32 s100, s32, s101
    v_mov_b32 v246, 0
    v_mov_b32 v247, s32
    s_waitcnt vmcnt(14)
    v_perm_b32 v80, v20, v16, s33
    v_perm_b32 v84, v20, v16, s34
    v_perm_b32 v88, v21, v17, s33
    v_perm_b32 v92, v21, v17, s34
    v_perm_b32 v96, v22, v18, s33
    v_perm_b32 v100, v22, v18, s34
    v_perm_b32 v104, v23, v19, s33
    v_perm_b32 v108, v23, v19, s34
    s_waitcnt vmcnt(12)
    v_perm_b32 v81, v28, v24, s33
    v_perm_b32 v85, v28, v24, s34
    v_perm_b32 v89, v29, v25, s33
    v_perm_b32 v93, v29, v25, s34
    v_perm_b32 v97, v30, v26, s33
    v_perm_b32 v101, v30, v26, s34
    v_perm_b32 v105, v31, v27, s33
    v_perm_b32 v109, v31, v27, s34
    s_waitcnt vmcnt(10)
    v_perm_b32 v82, v36, v32, s33
    v_perm_b32 v86, v36, v32, s34
    v_perm_b32 v90, v37, v33, s33
    v_perm_b32 v94, v37, v33, s34
    v_perm_b32 v98, v38, v34, s33
    v_perm_b32 v102, v38, v34, s34
    v_perm_b32 v106, v39, v35, s33
    v_perm_b32 v110, v39, v35, s34
    s_waitcnt vmcnt(8)
    v_perm_b32 v83, v44, v40, s33
    v_perm_b32 v87, v44, v40, s34
    v_perm_b32 v91, v45, v41, s33
    v_perm_b32 v95, v45, v41, s34
    v_perm_b32 v99, v46, v42, s33
    v_perm_b32 v103, v46, v42, s34
    v_perm_b32 v107, v47, v43, s33
    v_perm_b32 v111, v47, v43, s34
    s_waitcnt vmcnt(6)
    v_perm_b32 v16, v52, v48, s33
    v_perm_b32 v20, v52, v48, s34
    v_perm_b32 v24, v53, v49, s33
    v_perm_b32 v28, v53, v49, s34
    v_perm_b32 v32, v54, v50, s33
    v_perm_b32 v36, v54, v50, s34
    v_perm_b32 v40, v55, v51, s33
    v_perm_b32 v44, v55, v51, s34
    s_waitcnt vmcnt(4)
    v_perm_b32 v17, v60, v56, s33
    v_perm_b32 v21, v60, v56, s34
    v_perm_b32 v25, v61, v57, s33
    v_perm_b32 v29, v61, v57, s34
    v_perm_b32 v33, v62, v58, s33
    v_perm_b32 v37, v62, v58, s34
    v_perm_b32 v41, v63, v59, s33
    v_perm_b32 v45, v63, v59, s34
    s_waitcnt vmcnt(2)
    v_perm_b32 v18, v68, v64, s33
    v_perm_b32 v22, v68, v64, s34
    v_perm_b32 v26, v69, v65, s33
    v_perm_b32 v30, v69, v65, s34
    v_perm_b32 v34, v70, v66, s33
    v_perm_b32 v38, v70, v66, s34
    v_perm_b32 v42, v71, v67, s33
    v_perm_b32 v46, v71, v67, s34
    s_waitcnt vmcnt(0)
    v_perm_b32 v19, v76, v72, s33
    v_perm_b32 v23, v76, v72, s34
    v_perm_b32 v27, v77, v73, s33
    v_perm_b32 v31, v77, v73, s34
    v_perm_b32 v35, v78, v74, s33
    v_perm_b32 v39, v78, v74, s34
    v_perm_b32 v43, v79, v75, s33
    v_perm_b32 v47, v79, v75, s34
    ds_read_b64 v[128:129], v12
    s_waitcnt lgkmcnt(0)
    v_readfirstlane_b32 s42, v128
    v_readfirstlane_b32 s43, v129
    s_nop 0
    s_cmp_eq_u32 s43, s32
    s_cselect_b32 s42, s42, 0
    s_and_b32 s42, s42, 8192
    s_add_u32 s40, s40, s42
    s_add_u32 s41, s40, 16384
    s_mov_b32 s35, 0
L_ph_4:
    buffer_load_dwordx4 v[112:115], v9, s[48:51], s40 offen sc1
    buffer_load_dwordx4 v[116:119], v9, s[48:51], s41 offen sc1
    buffer_load_dwordx4 v[120:123], v8, s[48:51], s40 offen sc1
    buffer_load_dwordx4 v[124:127], v8, s[48:51], s41 offen sc1
    s_add_u32 s35, s35, 1
    s_cmp_ge_u32 s35, 256
    s_cbranch_scc1 L_ph_4_rare
L_ph_4_back:
    s_waitcnt vmcnt(0)
    v_bitop3_b32 v15, v115, v119, s32 bitop3:0x7e
    v_bitop3_b32 v15, v15, v123, s32 bitop3:0xf6
    v_bitop3_b32 v15, v15, v127, s32 bitop3:0xf6
    v_cmp_ne_u32 vcc, 0, v15
    s_cbranch_vccnz L_ph_4
    v_pk_add_f32 v[218:219], v[112:113], v[116:117]
    v_pk_add_f32 v[216:217], v[120:121], v[124:125]
    v_cvt_pk_bf16_f32 v218, 0, v218
    v_cvt_pk_bf16_f32 v219, 0, v219
    v_add_f32 v218, 1.0, v218
    v_add_f32 v219, 1.0, v219
    v_cvt_pk_bf16_f32 v216, 0, v216
    v_cvt_pk_bf16_f32 v217, 0, v217
    v_cvt_pk_bf16_f32 v218, 0, v218
    v_cvt_pk_bf16_f32 v219, 0, v219
    v_pk_mul_f32 v[218:219], v[218:219], v[224:225]
    v_cvt_pk_bf16_f32 v218, 0, v218
    v_cvt_pk_bf16_f32 v219, 0, v219
    v_pk_add_f32 v[218:219], v[218:219], v[216:217]
    v_cvt_pk_bf16_f32 v227, v218, v219
    ds_write_b32 v7, v227 offset:8192
    ds_read_b128 v[208:211], v10 offset:8192
    ds_read_b128 v[212:215], v10 offset:8320
    s_waitcnt lgkmcnt(1)
    v_mfma_f32_16x16x32_bf16 v[176:179], v[208:211], v[80:83], 0
    v_mfma_f32_16x16x32_bf16 v[180:183], v[208:211], v[84:87], 0
    v_mfma_f32_16x16x32_bf16 v[184:187], v[208:211], v[88:91], 0
    v_mfma_f32_16x16x32_bf16 v[188:191], v[208:211], v[92:95], 0
    v_mfma_f32_16x16x32_bf16 v[192:195], v[208:211], v[96:99], 0
    v_mfma_f32_16x16x32_bf16 v[196:199], v[208:211], v[100:103], 0
    v_mfma_f32_16x16x32_bf16 v[200:203], v[208:211], v[104:107], 0
    v_mfma_f32_16x16x32_bf16 v[204:207], v[208:211], v[108:111], 0
    s_waitcnt lgkmcnt(0)
    v_mfma_f32_16x16x32_bf16 v[176:179], v[212:215], v[16:19], v[176:179]
    v_mfma_f32_16x16x32_bf16 v[180:183], v[212:215], v[20:23], v[180:183]
    v_mfma_f32_16x16x32_bf16 v[184:187], v[212:215], v[24:27], v[184:187]
    v_mfma_f32_16x16x32_bf16 v[188:191], v[212:215], v[28:31], v[188:191]
    v_mfma_f32_16x16x32_bf16 v[192:195], v[212:215], v[32:35], v[192:195]
    v_mfma_f32_16x16x32_bf16 v[196:199], v[212:215], v[36:39], v[196:199]
    v_mfma_f32_16x16x32_bf16 v[200:203], v[212:215], v[40:43], v[200:203]
    v_mfma_f32_16x16x32_bf16 v[204:207], v[212:215], v[44:47], v[204:207]
    s_mov_b64 exec, s[56:57]
    s_nop 0
    ds_write2_b32 v11, v176, v180 offset0:0 offset1:1
    s_nop 0
    ds_write2_b32 v11, v184, v188 offset0:2 offset1:3
    s_nop 0
    ds_write2_b32 v11, v192, v196 offset0:4 offset1:5
    s_nop 0
    ds_write2_b32 v11, v200, v204 offset0:6 offset1:7
    s_mov_b64 exec, -1
    s_waitcnt lgkmcnt(0)
    s_barrier
    s_cmp_lg_u32 s3, 0
    s_cbranch_scc1 L_b_skipq
    ds_read_b128 v[48:51], v8 offset:0
    ds_read_b128 v[52:55], v8 offset:256
    ds_read_b128 v[56:59], v8 offset:512
    ds_read_b128 v[60:63], v8 offset:768
    ds_read_b128 v[64:67], v8 offset:1024
    ds_read_b128 v[68:71], v8 offset:1280
    ds_read_b128 v[72:75], v8 offset:1536
    ds_read_b128 v[76:79], v8 offset:1792
    s_waitcnt lgkmcnt(6)
    v_pk_add_f32 v[48:49], v[48:49], v[52:53]
    v_pk_add_f32 v[50:51], v[50:51], v[54:55]
    s_waitcnt lgkmcnt(4)
    v_pk_add_f32 v[56:57], v[56:57], v[60:61]
    v_pk_add_f32 v[58:59], v[58:59], v[62:63]
    s_waitcnt lgkmcnt(2)
    v_pk_add_f32 v[64:65], v[64:65], v[68:69]
    v_pk_add_f32 v[66:67], v[66:67], v[70:71]
    s_waitcnt lgkmcnt(0)
    v_pk_add_f32 v[72:73], v[72:73], v[76:77]
    v_pk_add_f32 v[74:75], v[74:75], v[78:79]
    v_pk_add_f32 v[48:49], v[48:49], v[56:57]
    v_pk_add_f32 v[50:51], v[50:51], v[58:59]
    v_pk_add_f32 v[64:65], v[64:65], v[72:73]
    v_pk_add_f32 v[66:67], v[66:67], v[74:75]
    v_pk_add_f32 v[48:49], v[48:49], v[64:65]
    v_pk_add_f32 v[50:51], v[50:51], v[66:67]
    v_cvt_pk_bf16_f32 v244, v48, v49
    v_cvt_pk_bf16_f32 v245, v50, v51
    s_mov_b64 exec, 0xffff
    buffer_store_dwordx4 v[244:247], v8, s[48:51], s36 offen
    buffer_store_dwordx4 v[244:247], v8, s[48:51], s38 offen sc1
    s_mov_b64 exec, -1
L_b_skipq:
    s_lshl_b32 s36, s1, 2
    s_add_u32 s36, s36, s3
    s_cmp_lg_u32 s36, 65
    s_cbranch_scc1 L_b_nonu
    ds_read_b32 v246, v12
    s_lshl_b32 s36, s0, 7
    s_add_u32 s36, s36, 98304
    v_mov_b32 v13, 0
    s_mov_b64 exec, 1
    s_waitcnt lgkmcnt(0)
    buffer_store_dwordx2 v[246:247], v13, s[48:51], s36 offen sc1
    s_mov_b64 exec, -1
L_b_nonu:
    s_lshl_b32 s43, s44, 7
    s_add_u32 s43, s43, 102400
    s_lshl_b32 s46, s44, 13
    s_add_u32 s46, s46, 131072
    s_add_u32 s47, s46, 4096
    s_and_b32 s41, s1, 7
    s_lshl_b32 s40, s41, 10
    s_add_u32 s40, s40, s46
    s_lshl_b32 s41, s41, 2
    s_add_u32 s41, s41, s3
    s_lshl_b32 s41, s41, 14
    s_lshl_b32 s42, s0, 19
    s_add_u32 s41, s41, s42
    s_add_u32 s41, s41, 384
    v_lshlrev_b32 v13, 10, v0
    v_lshlrev_b32 v9, 7, v0
    s_barrier
    s_mov_b64 exec, 0xffff
    buffer_load_dword v255, v13, s[96:99], s41 offen
    s_mov_b64 exec, 0xff
    buffer_load_dword v254, v9, s[48:51], s40 offen sc1
    s_mov_b64 exec, 1
    buffer_load_dword v253, v9, s[48:51], s43 offen sc1
    s_mov_b64 exec, -1
    buffer_load_dwordx4 v[144:147], v1, s[96:99], s16 offen offset:0 nt
    buffer_load_dwordx4 v[148:151], v1, s[96:99], s16 offen offset:1024 nt
    buffer_load_dwordx4 v[152:155], v1, s[96:99], s16 offen offset:2048 nt
    buffer_load_dwordx4 v[156:159], v1, s[96:99], s16 offen offset:3072 nt
    buffer_load_dwordx4 v[160:163], v1, s[96:99], s17 offen offset:0 nt
    buffer_load_dwordx4 v[164:167], v1, s[96:99], s17 offen offset:1024 nt
    buffer_load_dwordx4 v[168:171], v1, s[96:99], s17 offen offset:2048 nt
    buffer_load_dwordx4 v[172:175], v1, s[96:99], s17 offen offset:3072 nt
    buffer_load_dwordx4 v[176:179], v1, s[96:99], s18 offen offset:0 nt
    buffer_load_dwordx4 v[180:183], v1, s[96:99], s18 offen offset:1024 nt
    buffer_load_dwordx4 v[184:187], v1, s[96:99], s18 offen offset:2048 nt
    buffer_load_dwordx4 v[188:191], v1, s[96:99], s18 offen offset:3072 nt
    buffer_load_dwordx4 v[192:195], v1, s[96:99], s19 offen offset:0 nt
    buffer_load_dwordx4 v[196:199], v1, s[96:99], s19 offen offset:1024 nt
    buffer_load_dwordx4 v[200:203], v1, s[96:99], s19 offen offset:2048 nt
    buffer_load_dwordx4 v[204:207], v1, s[96:99], s19 offen offset:3072 nt
    v_lshlrev_b32 v9, 3, v3
    v_and_b32 v13, 31, v0
    v_lshrrev_b32 v7, 5, v0
    v_lshl_add_u32 v13, v13, 1, v7
    v_and_b32 v6, 15, v13
    v_lshrrev_b32 v13, 4, v13
    v_lshlrev_b32 v13, 2, v13
    v_lshl_add_u32 v13, v6, 4, v13
    v_add_u32 v13, s39, v13
    v_lshlrev_b32 v12, 4, v3
    v_lshl_add_u32 v7, v2, 15, v12
    s_and_b32 s42, s0, 3
    s_lshl_b32 s42, s42, 11
    s_lshr_b32 s58, s0, 2
    s_lshl_b32 s58, s58, 14
    s_add_u32 s42, s42, s58
    s_lshl_b32 s58, s45, 8
    s_add_u32 s42, s42, s58
    s_and_b32 s58, s3, 1
    s_lshl_b32 s58, s58, 17
    s_add_u32 s42, s42, s58
    s_lshr_b32 s58, s3, 1
    s_lshl_b32 s58, s58, 13
    s_add_u32 s42, s42, s58
    s_add_u32 s42, s42, 1179648
    v_mov_b32 v6, s32
    v_add_u32 v11, 2048, v11
    s_waitcnt vmcnt(14)
    v_perm_b32 v208, v148, v144, s33
    v_perm_b32 v212, v148, v144, s34
    v_perm_b32 v216, v149, v145, s33
    v_perm_b32 v220, v149, v145, s34
    v_perm_b32 v224, v150, v146, s33
    v_perm_b32 v228, v150, v146, s34
    v_perm_b32 v232, v151, v147, s33
    v_perm_b32 v236, v151, v147, s34
    s_waitcnt vmcnt(12)
    v_perm_b32 v209, v156, v152, s33
    v_perm_b32 v213, v156, v152, s34
    v_perm_b32 v217, v157, v153, s33
    v_perm_b32 v221, v157, v153, s34
    v_perm_b32 v225, v158, v154, s33
    v_perm_b32 v229, v158, v154, s34
    v_perm_b32 v233, v159, v155, s33
    v_perm_b32 v237, v159, v155, s34
    s_waitcnt vmcnt(10)
    v_perm_b32 v210, v164, v160, s33
    v_perm_b32 v214, v164, v160, s34
    v_perm_b32 v218, v165, v161, s33
    v_perm_b32 v222, v165, v161, s34
    v_perm_b32 v226, v166, v162, s33
    v_perm_b32 v230, v166, v162, s34
    v_perm_b32 v234, v167, v163, s33
    v_perm_b32 v238, v167, v163, s34
    s_waitcnt vmcnt(8)
    v_perm_b32 v211, v172, v168, s33
    v_perm_b32 v215, v172, v168, s34
    v_perm_b32 v219, v173, v169, s33
    v_perm_b32 v223, v173, v169, s34
    v_perm_b32 v227, v174, v170, s33
    v_perm_b32 v231, v174, v170, s34
    v_perm_b32 v235, v175, v171, s33
    v_perm_b32 v239, v175, v171, s34
    s_waitcnt vmcnt(6)
    v_perm_b32 v144, v180, v176, s33
    v_perm_b32 v148, v180, v176, s34
    v_perm_b32 v152, v181, v177, s33
    v_perm_b32 v156, v181, v177, s34
    v_perm_b32 v160, v182, v178, s33
    v_perm_b32 v164, v182, v178, s34
    v_perm_b32 v168, v183, v179, s33
    v_perm_b32 v172, v183, v179, s34
    s_waitcnt vmcnt(4)
    v_perm_b32 v145, v188, v184, s33
    v_perm_b32 v149, v188, v184, s34
    v_perm_b32 v153, v189, v185, s33
    v_perm_b32 v157, v189, v185, s34
    v_perm_b32 v161, v190, v186, s33
    v_perm_b32 v165, v190, v186, s34
    v_perm_b32 v169, v191, v187, s33
    v_perm_b32 v173, v191, v187, s34
    s_waitcnt vmcnt(2)
    v_perm_b32 v146, v196, v192, s33
    v_perm_b32 v150, v196, v192, s34
    v_perm_b32 v154, v197, v193, s33
    v_perm_b32 v158, v197, v193, s34
    v_perm_b32 v162, v198, v194, s33
    v_perm_b32 v166, v198, v194, s34
    v_perm_b32 v170, v199, v195, s33
    v_perm_b32 v174, v199, v195, s34
    buffer_load_dwordx2 v[240:241], v9, s[48:51], s43 offen sc1
    buffer_load_dwordx4 v[16:19], v8, s[48:51], s46 offen offset:0 sc1
    buffer_load_dwordx4 v[20:23], v8, s[48:51], s46 offen offset:1024 sc1
    buffer_load_dwordx4 v[24:27], v8, s[48:51], s46 offen offset:2048 sc1
    buffer_load_dwordx4 v[28:31], v8, s[48:51], s46 offen offset:3072 sc1
    buffer_load_dwordx4 v[32:35], v8, s[48:51], s47 offen offset:0 sc1
    buffer_load_dwordx4 v[36:39], v8, s[48:51], s47 offen offset:1024 sc1
    buffer_load_dwordx4 v[40:43], v8, s[48:51], s47 offen offset:2048 sc1
    buffer_load_dwordx4 v[44:47], v8, s[48:51], s47 offen offset:3072 sc1
    s_waitcnt vmcnt(9)
    v_perm_b32 v147, v204, v200, s33
    v_perm_b32 v151, v204, v200, s34
    v_perm_b32 v155, v205, v201, s33
    v_perm_b32 v159, v205, v201, s34
    v_perm_b32 v163, v206, v202, s33
    v_perm_b32 v167, v206, v202, s34
    v_perm_b32 v171, v207, v203, s33
    v_perm_b32 v175, v207, v203, s34
    s_waitcnt vmcnt(8)
    v_cmp_ne_u32 vcc, s32, v241
    s_cbranch_vccz L_sok
    s_mov_b32 s35, 0
    buffer_load_dwordx2 v[240:241], v9, s[48:51], s43 offen sc1
L_psx_5:
    buffer_load_dwordx2 v[240:241], v9, s[48:51], s43 offen sc1
    s_add_u32 s35, s35, 1
    s_cmp_ge_u32 s35, 256
    s_cbranch_scc1 L_psx_5_rare
L_psx_5_back:
    s_waitcnt vmcnt(1)
    v_cmp_ne_u32 vcc, s32, v241
    s_cbranch_vccnz L_psx_5
    buffer_load_dwordx4 v[16:19], v8, s[48:51], s46 offen offset:0 sc1
    buffer_load_dwordx4 v[20:23], v8, s[48:51], s46 offen offset:1024 sc1
    buffer_load_dwordx4 v[24:27], v8, s[48:51], s46 offen offset:2048 sc1
    buffer_load_dwordx4 v[28:31], v8, s[48:51], s46 offen offset:3072 sc1
    buffer_load_dwordx4 v[32:35], v8, s[48:51], s47 offen offset:0 sc1
    buffer_load_dwordx4 v[36:39], v8, s[48:51], s47 offen offset:1024 sc1
    buffer_load_dwordx4 v[40:43], v8, s[48:51], s47 offen offset:2048 sc1
    buffer_load_dwordx4 v[44:47], v8, s[48:51], s47 offen offset:3072 sc1
L_sok:
    v_max_f32_dpp v242, v240, v240 row_ror:8 row_mask:0xf bank_mask:0xf
    s_nop 1
    v_max_f32_dpp v242, v242, v242 row_ror:4 row_mask:0xf bank_mask:0xf
    s_nop 1
    v_max_f32_dpp v242, v242, v242 row_ror:2 row_mask:0xf bank_mask:0xf
    s_nop 1
    v_max_f32_dpp v242, v242, v242 row_ror:1 row_mask:0xf bank_mask:0xf
    v_sub_f32 v242, v240, v242
    v_exp_f32 v242, v242
    s_nop 1
    v_add_f32_dpp v243, v242, v242 row_ror:8 row_mask:0xf bank_mask:0xf
    s_nop 1
    v_add_f32_dpp v243, v243, v243 row_ror:4 row_mask:0xf bank_mask:0xf
    s_nop 1
    v_add_f32_dpp v243, v243, v243 row_ror:2 row_mask:0xf bank_mask:0xf
    s_nop 1
    v_add_f32_dpp v243, v243, v243 row_ror:1 row_mask:0xf bank_mask:0xf
    v_rcp_f32 v243, v243
    s_nop 0
    v_mul_f32 v242, v242, v243
    s_nop 1
    v_mov_b32_dpp v48, v242 row_newbcast:0 row_mask:0x3 bank_mask:0xf
    s_nop 1
    v_mov_b32_dpp v48, v242 row_newbcast:1 row_mask:0xc bank_mask:0xf
    v_mov_b32_dpp v50, v242 row_newbcast:2 row_mask:0x3 bank_mask:0xf
    s_nop 1
    v_mov_b32_dpp v50, v242 row_newbcast:3 row_mask:0xc bank_mask:0xf
    v_mov_b32_dpp v52, v242 row_newbcast:4 row_mask:0x3 bank_mask:0xf
    s_nop 1
    v_mov_b32_dpp v52, v242 row_newbcast:5 row_mask:0xc bank_mask:0xf
    v_mov_b32_dpp v54, v242 row_newbcast:6 row_mask:0x3 bank_mask:0xf
    s_nop 1
    v_mov_b32_dpp v54, v242 row_newbcast:7 row_mask:0xc bank_mask:0xf
    v_mov_b32_dpp v56, v242 row_newbcast:8 row_mask:0x3 bank_mask:0xf
    s_nop 1
    v_mov_b32_dpp v56, v242 row_newbcast:9 row_mask:0xc bank_mask:0xf
    v_mov_b32_dpp v58, v242 row_newbcast:10 row_mask:0x3 bank_mask:0xf
    s_nop 1
    v_mov_b32_dpp v58, v242 row_newbcast:11 row_mask:0xc bank_mask:0xf
    v_mov_b32_dpp v60, v242 row_newbcast:12 row_mask:0x3 bank_mask:0xf
    s_nop 1
    v_mov_b32_dpp v60, v242 row_newbcast:13 row_mask:0xc bank_mask:0xf
    v_mov_b32_dpp v62, v242 row_newbcast:14 row_mask:0x3 bank_mask:0xf
    s_nop 1
    v_mov_b32_dpp v62, v242 row_newbcast:15 row_mask:0xc bank_mask:0xf
    v_mov_b32 v49, v48
    v_mov_b32 v51, v50
    v_mov_b32 v53, v52
    v_mov_b32 v55, v54
    v_mov_b32 v57, v56
    v_mov_b32 v59, v58
    v_mov_b32 v61, v60
    v_mov_b32 v63, v62
    s_mov_b32 s35, 0
    s_branch L_pp_6_back
L_pp_6:
    buffer_load_dwordx4 v[16:19], v8, s[48:51], s46 offen offset:0 sc1
    buffer_load_dwordx4 v[20:23], v8, s[48:51], s46 offen offset:1024 sc1
    buffer_load_dwordx4 v[24:27], v8, s[48:51], s46 offen offset:2048 sc1
    buffer_load_dwordx4 v[28:31], v8, s[48:51], s46 offen offset:3072 sc1
    buffer_load_dwordx4 v[32:35], v8, s[48:51], s47 offen offset:0 sc1
    buffer_load_dwordx4 v[36:39], v8, s[48:51], s47 offen offset:1024 sc1
    buffer_load_dwordx4 v[40:43], v8, s[48:51], s47 offen offset:2048 sc1
    buffer_load_dwordx4 v[44:47], v8, s[48:51], s47 offen offset:3072 sc1
    s_add_u32 s35, s35, 1
    s_cmp_ge_u32 s35, 256
    s_cbranch_scc1 L_pp_6_rare
L_pp_6_back:
    s_waitcnt vmcnt(0)
    v_xor_b32 v17, s100, v17
    v_xor_b32 v19, s100, v19
    v_xor_b32 v21, s100, v21
    v_xor_b32 v23, s100, v23
    v_xor_b32 v25, s100, v25
    v_xor_b32 v27, s100, v27
    v_xor_b32 v29, s100, v29
    v_xor_b32 v31, s100, v31
    v_xor_b32 v33, s100, v33
    v_xor_b32 v35, s100, v35
    v_xor_b32 v37, s100, v37
    v_xor_b32 v39, s100, v39
    v_xor_b32 v41, s100, v41
    v_xor_b32 v43, s100, v43
    v_xor_b32 v45, s100, v45
    v_xor_b32 v47, s100, v47
    v_or_b32 v15, v17, v19
    v_or3_b32 v15, v15, v21, v23
    v_or3_b32 v15, v15, v25, v27
    v_or3_b32 v15, v15, v29, v31
    v_or3_b32 v15, v15, v33, v35
    v_or3_b32 v15, v15, v37, v39
    v_or3_b32 v15, v15, v41, v43
    v_or3_b32 v15, v15, v45, v47
    v_and_b32 v15, 0xff, v15
    v_cmp_ne_u32 vcc, 0, v15
    s_cbranch_vccnz L_pp_6
    v_pk_mul_f32 v[64:65], v[16:17], v[48:49]
    v_pk_mul_f32 v[68:69], v[20:21], v[50:51]
    v_pk_mul_f32 v[66:67], v[18:19], v[48:49]
    v_pk_mul_f32 v[70:71], v[22:23], v[50:51]
    v_pk_fma_f32 v[64:65], v[24:25], v[52:53], v[64:65]
    v_pk_fma_f32 v[66:67], v[26:27], v[52:53], v[66:67]
    v_pk_fma_f32 v[68:69], v[28:29], v[54:55], v[68:69]
    v_pk_fma_f32 v[70:71], v[30:31], v[54:55], v[70:71]
    v_pk_fma_f32 v[64:65], v[32:33], v[56:57], v[64:65]
    v_pk_fma_f32 v[66:67], v[34:35], v[56:57], v[66:67]
    v_pk_fma_f32 v[68:69], v[36:37], v[58:59], v[68:69]
    v_pk_fma_f32 v[70:71], v[38:39], v[58:59], v[70:71]
    v_pk_fma_f32 v[64:65], v[40:41], v[60:61], v[64:65]
    v_pk_fma_f32 v[66:67], v[42:43], v[60:61], v[66:67]
    v_pk_fma_f32 v[68:69], v[44:45], v[62:63], v[68:69]
    v_pk_fma_f32 v[70:71], v[46:47], v[62:63], v[70:71]
    v_pk_add_f32 v[64:65], v[64:65], v[68:69]
    v_pk_add_f32 v[66:67], v[66:67], v[70:71]
    s_nop 1
    v_permlane32_swap_b32 v64, v66
    v_permlane32_swap_b32 v65, v67
    v_pk_add_f32 v[64:65], v[64:65], v[66:67]
    v_cvt_pk_bf16_f32 v64, v64, v65
    ds_write_b32 v13, v64 offset:8192
    ds_read_b128 v[112:115], v10 offset:8192
    ds_read_b128 v[116:119], v10 offset:8320
    s_waitcnt lgkmcnt(1)
    v_mfma_f32_16x16x32_bf16 v[80:83], v[112:115], v[208:211], 0
    v_mfma_f32_16x16x32_bf16 v[84:87], v[112:115], v[212:215], 0
    v_mfma_f32_16x16x32_bf16 v[88:91], v[112:115], v[216:219], 0
    v_mfma_f32_16x16x32_bf16 v[92:95], v[112:115], v[220:223], 0
    v_mfma_f32_16x16x32_bf16 v[96:99], v[112:115], v[224:227], 0
    v_mfma_f32_16x16x32_bf16 v[100:103], v[112:115], v[228:231], 0
    v_mfma_f32_16x16x32_bf16 v[104:107], v[112:115], v[232:235], 0
    v_mfma_f32_16x16x32_bf16 v[108:111], v[112:115], v[236:239], 0
    s_waitcnt lgkmcnt(0)
    v_mfma_f32_16x16x32_bf16 v[80:83], v[116:119], v[144:147], v[80:83]
    v_mfma_f32_16x16x32_bf16 v[84:87], v[116:119], v[148:151], v[84:87]
    v_mfma_f32_16x16x32_bf16 v[88:91], v[116:119], v[152:155], v[88:91]
    v_mfma_f32_16x16x32_bf16 v[92:95], v[116:119], v[156:159], v[92:95]
    v_mfma_f32_16x16x32_bf16 v[96:99], v[116:119], v[160:163], v[96:99]
    v_mfma_f32_16x16x32_bf16 v[100:103], v[116:119], v[164:167], v[100:103]
    v_mfma_f32_16x16x32_bf16 v[104:107], v[116:119], v[168:171], v[104:107]
    v_mfma_f32_16x16x32_bf16 v[108:111], v[116:119], v[172:175], v[108:111]
    s_mov_b64 exec, s[56:57]
    s_nop 0
    ds_write2_b32 v11, v80, v84 offset0:0 offset1:1
    s_nop 0
    ds_write2_b32 v11, v88, v92 offset0:2 offset1:3
    s_nop 0
    ds_write2_b32 v11, v96, v100 offset0:4 offset1:5
    s_nop 0
    ds_write2_b32 v11, v104, v108 offset0:6 offset1:7
    s_mov_b64 exec, -1
    s_waitcnt lgkmcnt(0)
    s_barrier
    ds_read_b128 v[16:19], v12 offset:2048
    ds_read_b128 v[20:23], v12 offset:2304
    ds_read_b128 v[24:27], v12 offset:2560
    ds_read_b128 v[28:31], v12 offset:2816
    ds_read_b128 v[32:35], v12 offset:3072
    ds_read_b128 v[36:39], v12 offset:3328
    ds_read_b128 v[40:43], v12 offset:3584
    ds_read_b128 v[44:47], v12 offset:3840
    s_waitcnt lgkmcnt(6)
    v_pk_add_f32 v[16:17], v[16:17], v[20:21]
    v_pk_add_f32 v[18:19], v[18:19], v[22:23]
    s_waitcnt lgkmcnt(4)
    v_pk_add_f32 v[24:25], v[24:25], v[28:29]
    v_pk_add_f32 v[26:27], v[26:27], v[30:31]
    s_waitcnt lgkmcnt(2)
    v_pk_add_f32 v[32:33], v[32:33], v[36:37]
    v_pk_add_f32 v[34:35], v[34:35], v[38:39]
    s_waitcnt lgkmcnt(0)
    v_pk_add_f32 v[40:41], v[40:41], v[44:45]
    v_pk_add_f32 v[42:43], v[42:43], v[46:47]
    v_pk_add_f32 v[16:17], v[16:17], v[24:25]
    v_pk_add_f32 v[18:19], v[18:19], v[26:27]
    v_pk_add_f32 v[32:33], v[32:33], v[40:41]
    v_pk_add_f32 v[34:35], v[34:35], v[42:43]
    v_pk_add_f32 v[16:17], v[16:17], v[32:33]
    v_pk_add_f32 v[18:19], v[18:19], v[34:35]
    v_bfi_b32 v17, s101, v6, v17
    v_bfi_b32 v19, s101, v6, v19
    buffer_store_dwordx4 v[16:19], v7, s[48:51], s42 offen sc1
    s_branch L_end
    .p2align 6
L_attk2:
    v_and_b32 v9, 3, v3
    v_lshrrev_b32 v10, 2, v3
    v_lshl_add_u32 v9, v9, 2, v10
    v_xor_b32 v10, v2, v3
    v_lshlrev_b32 v10, 4, v10
    v_lshl_add_u32 v9, v9, 8, v10
    v_add_u32 v9, s38, v9
    v_xor_b32 v10, 64, v9
    v_xor_b32 v12, 128, v9
    v_xor_b32 v13, 192, v9
    v_and_b32 v1, 3, v3
    v_lshlrev_b32 v4, 8, v1
    v_lshl_add_u32 v4, v2, 4, v4
    v_add_u32 v4, 0x10000, v4
    s_lshl_b32 s46, s3, 3
    v_lshl_add_u32 v6, v1, 5, s46
    v_add_u32 v6, 0x10400, v6
    v_lshlrev_b32 v5, 7, v2
    v_lshl_add_u32 v5, v1, 5, v5
    v_lshrrev_b32 v7, 2, v3
    v_lshl_add_u32 v5, v7, 3, v5
    s_lshl_b32 s46, s3, 9
    s_add_u32 s46, s46, 0x12800
    v_add_u32 v5, s46, v5
    v_lshlrev_b32 v7, 3, v0
    v_add_u32 v7, 0x10000, v7
    s_mov_b32 s58, 0x3db504f3
    s_mov_b32 s59, 0x3fb8aa3b
    s_lshl_b32 s46, s0, 11
    s_add_u32 s46, s46, 65536
    s_waitcnt lgkmcnt(0)
    s_mul_i32 s32, s28, 0x9E3779B5
    s_add_u32 s32, s32, 0x7F4A7C15
    s_movk_i32 s101, 0xff
L_tg_7:
    s_xor_b32 s100, s32, s28
    s_and_b32 s100, s100, s101
    s_cbranch_scc0 L_tg_7_bump
    s_xor_b32 s100, s32, s29
    s_and_b32 s100, s100, s101
    s_cbranch_scc0 L_tg_7_bump
    s_xor_b32 s100, s32, s30
    s_and_b32 s100, s100, s101
    s_cbranch_scc0 L_tg_7_bump
    s_xor_b32 s100, s32, s31
    s_and_b32 s100, s100, s101
    s_cbranch_scc0 L_tg_7_bump
    s_and_b32 s100, s32, s101
    s_cmp_lg_u32 s3, 0
    s_cbranch_scc1 L_knl
    s_setprio 3
    s_waitcnt vmcnt(6)
    buffer_load_dwordx4 v[120:123], v8, s[48:51], s46 offen sc1
    buffer_load_dwordx4 v[124:127], v8, s[48:51], s46 offen offset:1024 sc1
    s_waitcnt vmcnt(4)
    buffer_load_dwordx4 v[120:123], v8, s[48:51], s46 offen sc1
    buffer_load_dwordx4 v[124:127], v8, s[48:51], s46 offen offset:1024 sc1
    s_waitcnt vmcnt(4)
    s_branch L_krd
L_knl:
    s_waitcnt vmcnt(0)
L_krd:
    ds_read_b128 v[16:19], v9 offset:0
    ds_read_b128 v[20:23], v10 offset:0
    ds_read_b128 v[24:27], v12 offset:0
    ds_read_b128 v[28:31], v13 offset:0
    ds_read_b128 v[32:35], v9 offset:4096
    ds_read_b128 v[36:39], v10 offset:4096
    ds_read_b128 v[40:43], v12 offset:4096
    ds_read_b128 v[44:47], v13 offset:4096
    ds_read_b128 v[48:51], v9 offset:8192
    ds_read_b128 v[52:55], v10 offset:8192
    ds_read_b128 v[56:59], v12 offset:8192
    ds_read_b128 v[60:63], v13 offset:8192
    ds_read_b128 v[64:67], v9 offset:12288
    ds_read_b128 v[68:71], v10 offset:12288
    ds_read_b128 v[72:75], v12 offset:12288
    ds_read_b128 v[76:79], v13 offset:12288
    s_cmp_lg_u32 s3, 0
    s_cbranch_scc1 L_kw
    s_mov_b32 s35, 0
L_pq_8:
    buffer_load_dwordx4 v[120:123], v8, s[48:51], s46 offen sc1
    buffer_load_dwordx4 v[124:127], v8, s[48:51], s46 offen offset:1024 sc1
    s_add_u32 s35, s35, 1
    s_cmp_ge_u32 s35, 256
    s_cbranch_scc1 L_pq_8_rare
L_pq_8_back:
    s_waitcnt vmcnt(4)
    v_bitop3_b32 v15, v123, v127, s32 bitop3:0x7e
    v_cmp_ne_u32 vcc, 0, v15
    s_cbranch_vccnz L_pq_8
    ds_write_b64 v7, v[120:121]
    ds_write_b64 v7, v[124:125] offset:512
L_kbail:
    ds_write_b32 v11, v11
    s_branch L_kgo
L_kw:
    ds_read_b32 v14, v11
    s_waitcnt lgkmcnt(0)
    v_cmp_eq_u32 vcc, 0, v14
    s_cbranch_vccnz L_kw
L_kgo:
    ds_read_b128 v[80:83], v4 offset:0
    ds_read_b128 v[84:87], v4 offset:64
    ds_read_b128 v[88:91], v4 offset:128
    ds_read_b128 v[92:95], v4 offset:192
    s_waitcnt lgkmcnt(3)
    v_mfma_f32_16x16x32_bf16 v[96:99], v[16:19], v[80:83], 0
    v_mfma_f32_16x16x32_bf16 v[100:103], v[32:35], v[80:83], 0
    v_mfma_f32_16x16x32_bf16 v[104:107], v[48:51], v[80:83], 0
    v_mfma_f32_16x16x32_bf16 v[108:111], v[64:67], v[80:83], 0
    s_waitcnt lgkmcnt(2)
    v_mfma_f32_16x16x32_bf16 v[96:99], v[20:23], v[84:87], v[96:99]
    v_mfma_f32_16x16x32_bf16 v[100:103], v[36:39], v[84:87], v[100:103]
    v_mfma_f32_16x16x32_bf16 v[104:107], v[52:55], v[84:87], v[104:107]
    v_mfma_f32_16x16x32_bf16 v[108:111], v[68:71], v[84:87], v[108:111]
    s_waitcnt lgkmcnt(1)
    v_mfma_f32_16x16x32_bf16 v[96:99], v[24:27], v[88:91], v[96:99]
    v_mfma_f32_16x16x32_bf16 v[100:103], v[40:43], v[88:91], v[100:103]
    v_mfma_f32_16x16x32_bf16 v[104:107], v[56:59], v[88:91], v[104:107]
    v_mfma_f32_16x16x32_bf16 v[108:111], v[72:75], v[88:91], v[108:111]
    s_waitcnt lgkmcnt(0)
    v_mfma_f32_16x16x32_bf16 v[96:99], v[28:31], v[92:95], v[96:99]
    v_mfma_f32_16x16x32_bf16 v[100:103], v[44:47], v[92:95], v[100:103]
    v_mfma_f32_16x16x32_bf16 v[104:107], v[60:63], v[92:95], v[104:107]
    v_mfma_f32_16x16x32_bf16 v[108:111], v[76:79], v[92:95], v[108:111]
    s_nop 5
    v_mov_b32_dpp v96, v100 quad_perm:[0,1,2,3] row_mask:0xf bank_mask:2
    v_mov_b32_dpp v97, v101 quad_perm:[0,1,2,3] row_mask:0xf bank_mask:2
    v_mov_b32_dpp v98, v102 quad_perm:[0,1,2,3] row_mask:0xf bank_mask:2
    v_mov_b32_dpp v99, v103 quad_perm:[0,1,2,3] row_mask:0xf bank_mask:2
    v_mov_b32_dpp v96, v104 quad_perm:[0,1,2,3] row_mask:0xf bank_mask:4
    v_mov_b32_dpp v97, v105 quad_perm:[0,1,2,3] row_mask:0xf bank_mask:4
    v_mov_b32_dpp v98, v106 quad_perm:[0,1,2,3] row_mask:0xf bank_mask:4
    v_mov_b32_dpp v99, v107 quad_perm:[0,1,2,3] row_mask:0xf bank_mask:4
    v_mov_b32_dpp v96, v108 quad_perm:[0,1,2,3] row_mask:0xf bank_mask:8
    v_mov_b32_dpp v97, v109 quad_perm:[0,1,2,3] row_mask:0xf bank_mask:8
    v_mov_b32_dpp v98, v110 quad_perm:[0,1,2,3] row_mask:0xf bank_mask:8
    v_mov_b32_dpp v99, v111 quad_perm:[0,1,2,3] row_mask:0xf bank_mask:8
    v_cvt_pk_bf16_f32 v96, 0, v96
    v_cvt_pk_bf16_f32 v97, 0, v97
    v_cvt_pk_bf16_f32 v98, 0, v98
    v_cvt_pk_bf16_f32 v99, 0, v99
    v_mul_f32 v96, s58, v96
    v_mul_f32 v97, s58, v97
    v_mul_f32 v98, s58, v98
    v_mul_f32 v99, s58, v99
    v_cvt_pk_bf16_f32 v96, 0, v96
    v_cvt_pk_bf16_f32 v97, 0, v97
    v_cvt_pk_bf16_f32 v98, 0, v98
    v_cvt_pk_bf16_f32 v99, 0, v99
    v_max_f32 v112, v96, v97
    v_max3_f32 v112, v112, v98, v99
    s_nop 1
    v_max_f32_dpp v112, v112, v112 row_ror:4 row_mask:0xf bank_mask:0xf
    s_nop 1
    v_max_f32_dpp v112, v112, v112 row_ror:8 row_mask:0xf bank_mask:0xf
    v_mov_b32 v14, v112
    s_nop 1
    v_permlane16_swap_b32 v14, v112
    v_max_f32 v112, v112, v14
    v_mov_b32 v14, v112
    s_nop 1
    v_permlane32_swap_b32 v14, v112
    v_max_f32 v112, v112, v14
    v_mul_f32 v112, s59, v112
    v_fma_f32 v96, v96, s59, -v112
    v_fma_f32 v97, v97, s59, -v112
    v_fma_f32 v98, v98, s59, -v112
    v_fma_f32 v99, v99, s59, -v112
    v_exp_f32 v96, v96
    v_exp_f32 v97, v97
    v_exp_f32 v98, v98
    v_exp_f32 v99, v99
    v_cvt_pk_bf16_f32 v14, v96, v97
    v_cvt_pk_bf16_f32 v15, v98, v99
    v_add_f32 v113, v96, v97
    v_add_f32 v114, v98, v99
    ds_write_b64 v5, v[14:15]
    v_add_f32 v113, v113, v114
    s_nop 1
    v_add_f32_dpp v113, v113, v113 row_ror:4 row_mask:0xf bank_mask:0xf
    s_nop 1
    v_add_f32_dpp v113, v113, v113 row_ror:8 row_mask:0xf bank_mask:0xf
    v_mov_b32 v114, v113
    s_nop 1
    v_permlane16_swap_b32 v114, v113
    v_add_f32 v113, v113, v114
    v_mov_b32 v114, v113
    s_nop 1
    v_permlane32_swap_b32 v114, v113
    v_add_f32 v113, v113, v114
    ds_write_b64 v6, v[112:113]
    s_waitcnt lgkmcnt(0)
    s_setprio 0
    v_lshlrev_b32 v5, 5, v1
    v_add_u32 v5, 0x10400, v5
    s_barrier
    s_cmp_lg_u32 s3, 2
    s_cbranch_scc1 L_nos
    ds_read_b128 v[100:103], v5
    ds_read_b128 v[104:107], v5 offset:16
    s_lshl_b32 s40, s0, 9
    s_lshl_b32 s41, s1, 3
    s_add_u32 s40, s40, s41
    s_add_u32 s40, s40, 102400
    s_add_u32 s41, s40, 2097152
    v_lshlrev_b32 v5, 7, v1
    v_mov_b32 v111, s32
    s_waitcnt lgkmcnt(0)
    v_max3_f32 v108, v100, v102, v104
    v_max_f32 v108, v108, v106
    v_sub_f32 v100, v100, v108
    v_sub_f32 v102, v102, v108
    v_sub_f32 v104, v104, v108
    v_sub_f32 v106, v106, v108
    v_exp_f32 v100, v100
    v_exp_f32 v102, v102
    v_exp_f32 v104, v104
    v_exp_f32 v106, v106
    v_mul_f32 v110, v100, v101
    v_fmac_f32 v110, v102, v103
    v_fmac_f32 v110, v104, v105
    v_fmac_f32 v110, v106, v107
    v_log_f32 v110, v110
    s_nop 0
    v_add_f32 v110, v110, v108
    s_mov_b64 exec, 0xf
    buffer_store_dwordx2 v[110:111], v5, s[48:51], s40 offen
    buffer_store_dwordx2 v[110:111], v5, s[48:51], s41 offen sc1
    s_mov_b64 exec, -1
L_nos:
    s_barrier
    s_barrier
    s_cmp_ge_u32 s1, 4
    s_cbranch_scc1 L_f
    s_cmp_lg_u32 s3, 1
    s_cbranch_scc1 L_end
    s_mov_b32 s94, 1024
    s_mov_b64 s[92:93], s[4:5]
    s_mov_b64 s[96:97], s[26:27]
    s_mov_b32 s98, 1024
    v_and_b32 v4, 7, v0
    v_lshrrev_b32 v5, 3, v0
    s_lshl_b32 s46, s1, 8
    s_and_b32 s47, s0, 1
    s_lshl_b32 s47, s47, 7
    s_add_u32 s46, s46, s47
    s_lshr_b32 s47, s0, 1
    s_lshl_b32 s47, s47, 2
    s_add_u32 s46, s46, s47
    v_lshl_add_u32 v9, v4, 4, s46
    buffer_load_dword v52, v9, s[92:95], 0 offen
    buffer_load_dword v53, v9, s[96:99], 0 offen
    v_lshrrev_b32 v6, 3, v9
    v_lshlrev_b32 v6, 4, v6
    s_bitcmp1_b32 s0, 1
    s_cselect_b64 s[42:43], -1, 0
    s_mov_b32 s36, 4096
    s_mov_b32 s37, 10240
    v_lshlrev_b32 v4, 3, v4
    v_and_b32 v7, 3, v5
    v_lshl_add_u32 v7, v7, 11, v4
    v_lshrrev_b32 v5, 2, v5
    v_lshl_add_u32 v7, v5, 14, v7
    s_lshl_b32 s39, s0, 7
    s_add_u32 s39, s39, 98304
    s_lshl_b32 s46, s2, 6
    s_lshl_b32 s38, s0, 15
    s_add_u32 s38, s38, 1179648
    v_sub_u32 v12, v7, v4
    v_lshl_add_u32 v12, v9, 1, v12
    v_mov_b32 v13, s32
    v_mov_b32 v10, 0
    s_mov_b32 s35, 0
L_pg_9:
    buffer_load_dwordx4 v[56:59], v6, s[48:51], s36 offen sc1
    buffer_load_dwordx4 v[60:63], v6, s[48:51], s37 offen sc1
    buffer_load_dwordx2 v[66:67], v10, s[48:51], s39 offen sc1
    buffer_load_dwordx4 v[104:107], v8, s[48:51], s37 offen sc1
    buffer_load_dwordx4 v[108:111], v8, s[48:51], s37 offen offset:1024 sc1
    s_add_u32 s35, s35, 1
    s_cmp_ge_u32 s35, 256
    s_cbranch_scc1 L_pg_9_rare
L_pg_9_back:
    s_waitcnt vmcnt(0)
    v_bitop3_b32 v15, v59, v63, s32 bitop3:0x7e
    v_bitop3_b32 v15, v15, v67, s32 bitop3:0xf6
    v_bitop3_b32 v15, v15, v107, s32 bitop3:0xf6
    v_bitop3_b32 v15, v15, v111, s32 bitop3:0xf6
    v_cmp_ne_u32 vcc, 0, v15
    s_cbranch_vccnz L_pg_9
    v_add_u32 v7, v7, v66
    v_add_u32 v12, v12, v66
    v_cndmask_b32 v58, v56, v57, s[42:43]
    v_cndmask_b32 v62, v60, v61, s[42:43]
    v_lshlrev_b32 v56, 16, v58
    v_and_b32 v57, 0xffff0000, v58
    v_lshlrev_b32 v60, 16, v62
    v_and_b32 v61, 0xffff0000, v62
    v_lshlrev_b32 v64, 16, v52
    v_and_b32 v65, 0xffff0000, v52
    s_add_u32 s47, s46, 1441792
    s_add_u32 s36, s47, 0
    s_add_u32 s37, s47, 32768
    s_add_u32 s39, s47, 65536
    s_add_u32 s40, s47, 98304
    s_add_u32 s41, s47, 131072
    s_add_u32 s44, s47, 163840
    s_add_u32 s45, s47, 196608
    buffer_load_dwordx2 v[72:73], v7, s[48:51], s36 offen sc1
    buffer_load_dwordx2 v[74:75], v7, s[48:51], s37 offen sc1
    buffer_load_dwordx2 v[76:77], v7, s[48:51], s39 offen sc1
    buffer_load_dwordx2 v[78:79], v7, s[48:51], s40 offen sc1
    buffer_load_dwordx2 v[80:81], v7, s[48:51], s41 offen sc1
    buffer_load_dwordx2 v[82:83], v7, s[48:51], s44 offen sc1
    buffer_load_dwordx2 v[84:85], v7, s[48:51], s45 offen sc1
    s_mov_b32 s35, 0
L_pxs_10:
    buffer_load_dwordx2 v[68:69], v12, s[48:51], s38 offen sc1
    s_add_u32 s35, s35, 1
    s_cmp_ge_u32 s35, 256
    s_cbranch_scc1 L_pxs_10_rare
L_pxs_10_back:
    s_waitcnt vmcnt(0)
    v_xor_b32 v69, s100, v69
    v_and_b32 v15, 0xff, v69
    v_cmp_ne_u32 vcc, 0, v15
    s_cbranch_vccnz L_pxs_10
    v_mov_b32 v70, v68
    v_mov_b32 v71, v69
    s_nop 0
    v_permlane16_swap_b32 v70, v68
    v_permlane16_swap_b32 v71, v69
    v_add_f32 v68, v68, v70
    v_add_f32 v69, v69, v71
    v_mov_b32 v70, v68
    v_mov_b32 v71, v69
    s_nop 0
    v_permlane32_swap_b32 v70, v68
    v_permlane32_swap_b32 v71, v69
    v_add_f32 v68, v68, v70
    v_add_f32 v69, v69, v71
    s_nop 0
    v_add_f32_dpp v68, v68, v68 row_ror:8 row_mask:0xf bank_mask:0xf
    v_add_f32_dpp v69, v69, v69 row_ror:8 row_mask:0xf bank_mask:0xf
    v_cvt_pk_bf16_f32 v68, 0, v68
    v_cvt_pk_bf16_f32 v69, 0, v69
    v_pk_mul_f32 v[68:69], v[68:69], v[56:57]
    v_cvt_pk_bf16_f32 v68, 0, v68
    v_cvt_pk_bf16_f32 v69, 0, v69
    v_pk_add_f32 v[64:65], v[64:65], v[68:69]
    v_cvt_pk_bf16_f32 v64, 0, v64
    v_cvt_pk_bf16_f32 v65, 0, v65
    s_mov_b32 s35, 0
    buffer_load_dwordx2 v[72:73], v7, s[48:51], s36 offen sc1
    buffer_load_dwordx2 v[74:75], v7, s[48:51], s37 offen sc1
    buffer_load_dwordx2 v[76:77], v7, s[48:51], s39 offen sc1
    buffer_load_dwordx2 v[78:79], v7, s[48:51], s40 offen sc1
    buffer_load_dwordx2 v[80:81], v7, s[48:51], s41 offen sc1
    buffer_load_dwordx2 v[82:83], v7, s[48:51], s44 offen sc1
    buffer_load_dwordx2 v[84:85], v7, s[48:51], s45 offen sc1
L_py_11:
    buffer_load_dwordx2 v[72:73], v7, s[48:51], s36 offen sc1
    buffer_load_dwordx2 v[74:75], v7, s[48:51], s37 offen sc1
    buffer_load_dwordx2 v[76:77], v7, s[48:51], s39 offen sc1
    buffer_load_dwordx2 v[78:79], v7, s[48:51], s40 offen sc1
    buffer_load_dwordx2 v[80:81], v7, s[48:51], s41 offen sc1
    buffer_load_dwordx2 v[82:83], v7, s[48:51], s44 offen sc1
    buffer_load_dwordx2 v[84:85], v7, s[48:51], s45 offen sc1
    s_add_u32 s35, s35, 1
    s_cmp_ge_u32 s35, 256
    s_cbranch_scc1 L_py_11_rare
L_py_11_back:
    s_waitcnt vmcnt(7)
    v_xor_b32 v88, s100, v73
    v_xor_b32 v89, s100, v75
    v_xor_b32 v90, s100, v77
    v_xor_b32 v91, s100, v79
    v_xor_b32 v92, s100, v81
    v_xor_b32 v93, s100, v83
    v_xor_b32 v94, s100, v85
    v_or3_b32 v15, v88, v89, v90
    v_or3_b32 v15, v15, v91, v92
    v_or3_b32 v15, v15, v93, v94
    v_and_b32 v15, 0xff, v15
    v_cmp_ne_u32 vcc, 0, v15
    s_cbranch_vccnz L_py_11
    v_add_f32 v100, v72, v74
    v_add_f32 v101, v88, v89
    v_add_f32 v102, v76, v78
    v_add_f32 v103, v90, v91
    v_add_f32 v104, v80, v82
    v_add_f32 v105, v92, v93
    v_pk_add_f32 v[100:101], v[100:101], v[102:103]
    v_add_f32 v104, v104, v84
    v_add_f32 v105, v105, v94
    v_pk_add_f32 v[100:101], v[100:101], v[104:105]
    s_nop 1
    v_add_f32_dpp v100, v100, v100 row_ror:8 row_mask:0xf bank_mask:0xf
    v_add_f32_dpp v101, v101, v101 row_ror:8 row_mask:0xf bank_mask:0xf
    v_mov_b32 v102, v100
    v_mov_b32 v103, v101
    s_nop 0
    v_permlane16_swap_b32 v102, v100
    v_permlane16_swap_b32 v103, v101
    v_add_f32 v100, v100, v102
    v_add_f32 v101, v101, v103
    v_mov_b32 v102, v100
    v_mov_b32 v103, v101
    s_nop 0
    v_permlane32_swap_b32 v102, v100
    v_permlane32_swap_b32 v103, v101
    v_add_f32 v100, v100, v102
    v_add_f32 v101, v101, v103
    v_cvt_pk_bf16_f32 v100, 0, v100
    v_cvt_pk_bf16_f32 v101, 0, v101
    v_pk_mul_f32 v[100:101], v[100:101], v[60:61]
    v_cvt_pk_bf16_f32 v100, 0, v100
    v_cvt_pk_bf16_f32 v101, 0, v101
    v_pk_add_f32 v[100:101], v[100:101], v[64:65]
    v_cvt_pk_bf16_f32 v104, v100, v101
    s_mov_b64 exec, 0xff
    buffer_store_dword v104, v9, s[96:99], 0 offen
    s_cmp_lg_u32 s2, 0
    s_cbranch_scc1 L_noep
    s_mov_b64 exec, 0xf
    v_lshlrev_b32 v10, 2, v0
    buffer_store_dword v13, v10, s[48:51], 0 offen sc1
L_noep:
    s_mov_b64 exec, -1
    s_branch L_end
    .p2align 6
L_attv2:
    v_and_b32 v13, 3, v3
    v_lshlrev_b32 v5, 5, v13
    v_add_u32 v5, 0x10400, v5
    v_lshlrev_b32 v4, 7, v2
    v_lshl_add_u32 v4, v13, 5, v4
    s_lshl_b32 s46, s39, 9
    s_add_u32 s47, s46, 0x12800
    v_add_u32 v4, s47, v4
    v_lshl_add_u32 v7, v0, 3, s46
    v_add_u32 v7, 0x10800, v7
    s_lshl_b32 s36, s0, 2
    s_add_u32 s36, s36, s39
    s_lshl_b32 s36, s36, 4
    s_add_u32 s36, s36, s1
    s_lshl_b32 s36, s36, 9
    s_add_u32 s36, s36, 131072
    s_add_u32 s38, s36, 2097152
    s_lshl_b32 s37, s39, 11
    v_lshl_add_u32 v9, v0, 3, s37
    v_add_u32 v9, 0x10800, v9
    v_add_u32 v10, 4096, v7
    v_add_u32 v212, 2048, v7
    v_add_u32 v213, 2048, v10
    s_lshl_b32 s37, s39, 3
    v_add_u32 v6, s37, v5
    s_mov_b32 s40, 0x000f000f
    s_mov_b32 s41, 0x000f000f
    s_lshl_b64 s[42:43], s[40:41], 4
    s_lshl_b64 s[44:45], s[40:41], 8
    s_lshl_b64 s[46:47], s[40:41], 12
    v_mov_b32 v144, 0
    v_mov_b32 v145, 0
    v_mov_b32 v146, 0
    v_mov_b32 v147, 0
    v_mov_b32 v148, 0
    v_mov_b32 v149, 0
    v_mov_b32 v150, 0
    v_mov_b32 v151, 0
    v_mov_b32 v152, 0
    v_mov_b32 v153, 0
    v_mov_b32 v154, 0
    v_mov_b32 v155, 0
    v_mov_b32 v156, 0
    v_mov_b32 v157, 0
    v_mov_b32 v158, 0
    v_mov_b32 v159, 0
    v_mov_b32 v160, 0
    v_mov_b32 v161, 0
    v_mov_b32 v162, 0
    v_mov_b32 v163, 0
    v_mov_b32 v164, 0
    v_mov_b32 v165, 0
    v_mov_b32 v166, 0
    v_mov_b32 v167, 0
    v_mov_b32 v168, 0
    v_mov_b32 v169, 0
    v_mov_b32 v170, 0
    v_mov_b32 v171, 0
    v_mov_b32 v172, 0
    v_mov_b32 v173, 0
    v_mov_b32 v174, 0
    v_mov_b32 v175, 0
    s_waitcnt lgkmcnt(0)
    s_mul_i32 s32, s28, 0x9E3779B5
    s_add_u32 s32, s32, 0x7F4A7C15
    s_movk_i32 s101, 0xff
L_tg_12:
    s_xor_b32 s100, s32, s28
    s_and_b32 s100, s100, s101
    s_cbranch_scc0 L_tg_12_bump
    s_xor_b32 s100, s32, s29
    s_and_b32 s100, s100, s101
    s_cbranch_scc0 L_tg_12_bump
    s_xor_b32 s100, s32, s30
    s_and_b32 s100, s100, s101
    s_cbranch_scc0 L_tg_12_bump
    s_xor_b32 s100, s32, s31
    s_and_b32 s100, s100, s101
    s_cbranch_scc0 L_tg_12_bump
    s_and_b32 s100, s32, s101
    v_mov_b32 v211, s32
    s_waitcnt vmcnt(14)
    v_perm_b32 v80, v20, v16, s33
    v_perm_b32 v84, v20, v16, s34
    v_perm_b32 v88, v21, v17, s33
    v_perm_b32 v92, v21, v17, s34
    v_perm_b32 v96, v22, v18, s33
    v_perm_b32 v100, v22, v18, s34
    v_perm_b32 v104, v23, v19, s33
    v_perm_b32 v108, v23, v19, s34
    s_waitcnt vmcnt(12)
    v_perm_b32 v81, v28, v24, s33
    v_perm_b32 v85, v28, v24, s34
    v_perm_b32 v89, v29, v25, s33
    v_perm_b32 v93, v29, v25, s34
    v_perm_b32 v97, v30, v26, s33
    v_perm_b32 v101, v30, v26, s34
    v_perm_b32 v105, v31, v27, s33
    v_perm_b32 v109, v31, v27, s34
    s_waitcnt vmcnt(10)
    v_perm_b32 v82, v36, v32, s33
    v_perm_b32 v86, v36, v32, s34
    v_perm_b32 v90, v37, v33, s33
    v_perm_b32 v94, v37, v33, s34
    v_perm_b32 v98, v38, v34, s33
    v_perm_b32 v102, v38, v34, s34
    v_perm_b32 v106, v39, v35, s33
    v_perm_b32 v110, v39, v35, s34
    s_waitcnt vmcnt(8)
    v_perm_b32 v83, v44, v40, s33
    v_perm_b32 v87, v44, v40, s34
    v_perm_b32 v91, v45, v41, s33
    v_perm_b32 v95, v45, v41, s34
    v_perm_b32 v99, v46, v42, s33
    v_perm_b32 v103, v46, v42, s34
    v_perm_b32 v107, v47, v43, s33
    v_perm_b32 v111, v47, v43, s34
    s_barrier
    ds_read_b128 v[192:195], v5
    ds_read_b128 v[196:199], v5 offset:16
    ds_read_b32 v12, v6
    s_mov_b64 exec, s[40:41]
    ds_read_b128 v[144:147], v4 offset:0
    s_mov_b64 exec, s[42:43]
    ds_read_b128 v[148:151], v4 offset:0
    s_mov_b64 exec, s[44:45]
    ds_read_b128 v[152:155], v4 offset:0
    s_mov_b64 exec, s[46:47]
    ds_read_b128 v[156:159], v4 offset:0
    s_mov_b64 exec, s[40:41]
    ds_read_b128 v[160:163], v4 offset:16
    s_mov_b64 exec, s[42:43]
    ds_read_b128 v[164:167], v4 offset:16
    s_mov_b64 exec, s[44:45]
    ds_read_b128 v[168:171], v4 offset:16
    s_mov_b64 exec, s[46:47]
    ds_read_b128 v[172:175], v4 offset:16
    s_mov_b64 exec, -1
    s_waitcnt lgkmcnt(7)
    v_mfma_f32_16x16x32_bf16 v[176:179], v[144:147], v[80:83], 0
    v_max3_f32 v200, v192, v194, v196
    v_max_f32 v200, v200, v198
    v_mfma_f32_16x16x32_bf16 v[180:183], v[144:147], v[84:87], 0
    v_sub_f32 v192, v192, v200
    v_sub_f32 v194, v194, v200
    s_waitcnt lgkmcnt(6)
    v_mfma_f32_16x16x32_bf16 v[176:179], v[148:151], v[88:91], v[176:179]
    v_sub_f32 v196, v196, v200
    v_sub_f32 v198, v198, v200
    v_mfma_f32_16x16x32_bf16 v[180:183], v[148:151], v[92:95], v[180:183]
    v_sub_f32 v12, v12, v200
    v_exp_f32 v192, v192
    s_waitcnt lgkmcnt(5)
    v_mfma_f32_16x16x32_bf16 v[176:179], v[152:155], v[96:99], v[176:179]
    v_exp_f32 v194, v194
    v_exp_f32 v196, v196
    v_mfma_f32_16x16x32_bf16 v[180:183], v[152:155], v[100:103], v[180:183]
    v_exp_f32 v198, v198
    v_exp_f32 v12, v12
    s_waitcnt lgkmcnt(4)
    v_mfma_f32_16x16x32_bf16 v[176:179], v[156:159], v[104:107], v[176:179]
    v_mul_f32 v201, v192, v193
    v_fmac_f32 v201, v194, v195
    v_mfma_f32_16x16x32_bf16 v[180:183], v[156:159], v[108:111], v[180:183]
    v_fmac_f32 v201, v196, v197
    v_fmac_f32 v201, v198, v199
    s_waitcnt vmcnt(6)
    v_perm_b32 v112, v52, v48, s33
    v_perm_b32 v116, v52, v48, s34
    v_perm_b32 v120, v53, v49, s33
    v_perm_b32 v124, v53, v49, s34
    v_perm_b32 v128, v54, v50, s33
    v_perm_b32 v132, v54, v50, s34
    v_perm_b32 v136, v55, v51, s33
    v_perm_b32 v140, v55, v51, s34
    s_waitcnt vmcnt(4)
    v_perm_b32 v113, v60, v56, s33
    v_perm_b32 v117, v60, v56, s34
    v_perm_b32 v121, v61, v57, s33
    v_perm_b32 v125, v61, v57, s34
    v_perm_b32 v129, v62, v58, s33
    v_perm_b32 v133, v62, v58, s34
    v_perm_b32 v137, v63, v59, s33
    v_perm_b32 v141, v63, v59, s34
    s_waitcnt vmcnt(2)
    v_perm_b32 v114, v68, v64, s33
    v_perm_b32 v118, v68, v64, s34
    v_perm_b32 v122, v69, v65, s33
    v_perm_b32 v126, v69, v65, s34
    v_perm_b32 v130, v70, v66, s33
    v_perm_b32 v134, v70, v66, s34
    v_perm_b32 v138, v71, v67, s33
    v_perm_b32 v142, v71, v67, s34
    s_waitcnt vmcnt(0)
    v_perm_b32 v115, v76, v72, s33
    v_perm_b32 v119, v76, v72, s34
    v_perm_b32 v123, v77, v73, s33
    v_perm_b32 v127, v77, v73, s34
    v_perm_b32 v131, v78, v74, s33
    v_perm_b32 v135, v78, v74, s34
    v_perm_b32 v139, v79, v75, s33
    v_perm_b32 v143, v79, v75, s34
    s_waitcnt lgkmcnt(0)
    v_mfma_f32_16x16x32_bf16 v[176:179], v[160:163], v[112:115], v[176:179]
    v_rcp_f32 v202, v201
    v_lshlrev_b32 v210, 3, v0
    v_mfma_f32_16x16x32_bf16 v[180:183], v[160:163], v[116:119], v[180:183]
    v_mul_f32 v12, v12, v202
    s_nop 1
    v_mov_b32_dpp v204, v12 quad_perm:[0,0,0,0] row_mask:0xf bank_mask:0xf
    v_mfma_f32_16x16x32_bf16 v[176:179], v[164:167], v[120:123], v[176:179]
    v_mov_b32_dpp v205, v12 quad_perm:[1,1,1,1] row_mask:0xf bank_mask:0xf
    v_mov_b32_dpp v206, v12 quad_perm:[2,2,2,2] row_mask:0xf bank_mask:0xf
    v_mfma_f32_16x16x32_bf16 v[180:183], v[164:167], v[124:127], v[180:183]
    v_mov_b32_dpp v207, v12 quad_perm:[3,3,3,3] row_mask:0xf bank_mask:0xf
    v_mfma_f32_16x16x32_bf16 v[176:179], v[168:171], v[128:131], v[176:179]
    v_mfma_f32_16x16x32_bf16 v[180:183], v[168:171], v[132:135], v[180:183]
    v_mfma_f32_16x16x32_bf16 v[176:179], v[172:175], v[136:139], v[176:179]
    v_mfma_f32_16x16x32_bf16 v[180:183], v[172:175], v[140:143], v[180:183]
    s_nop 6
    v_mul_f32 v176, v176, v204
    v_mul_f32 v180, v180, v204
    ds_write2_b32 v7, v176, v180 offset0:0 offset1:1
    v_mul_f32 v177, v177, v205
    v_mul_f32 v181, v181, v205
    ds_write2_b32 v212, v177, v181 offset0:0 offset1:1
    v_mul_f32 v178, v178, v206
    v_mul_f32 v182, v182, v206
    ds_write2_b32 v10, v178, v182 offset0:0 offset1:1
    v_mul_f32 v179, v179, v207
    v_mul_f32 v183, v183, v207
    ds_write2_b32 v213, v179, v183 offset0:0 offset1:1
    s_waitcnt lgkmcnt(0)
    s_barrier
    ds_read2st64_b64 v[48:51], v9 offset0:0 offset1:1
    ds_read2st64_b64 v[52:55], v9 offset0:2 offset1:3
    s_waitcnt lgkmcnt(1)
    v_pk_add_f32 v[48:49], v[48:49], v[50:51]
    s_waitcnt lgkmcnt(0)
    v_pk_add_f32 v[52:53], v[52:53], v[54:55]
    v_pk_add_f32 v[208:209], v[48:49], v[52:53]
    v_bfi_b32 v209, s101, v211, v209
    buffer_store_dwordx2 v[208:209], v210, s[48:51], s36 offen
    s_barrier
    s_waitcnt vmcnt(0)
    buffer_store_dwordx2 v[208:209], v210, s[48:51], s38 offen sc1
    s_branch L_end
    .p2align 6
L_g_rest:
    s_waitcnt lgkmcnt(0)
    s_add_u32 s48, s30, 532676608
    s_addc_u32 s49, s31, 0
    s_load_dwordx4 s[28:31], s[48:49], 0
    s_lshl_b32 s45, s0, 2
    s_add_u32 s45, s45, s1
    s_sub_u32 s45, s45, 28
    s_lshl_b32 s38, s45, 7
    s_add_u32 s37, s37, s38
    s_add_u32 s37, s37, 2048
    s_lshl_b32 s41, s45, 8
    s_add_u32 s41, s41, 4096
    s_waitcnt lgkmcnt(0)
    s_mul_i32 s32, s28, 0x9E3779B5
    s_add_u32 s32, s32, 0x7F4A7C15
    s_movk_i32 s101, 0xff
L_tg_13:
    s_xor_b32 s100, s32, s28
    s_and_b32 s100, s100, s101
    s_cbranch_scc0 L_tg_13_bump
    s_xor_b32 s100, s32, s29
    s_and_b32 s100, s100, s101
    s_cbranch_scc0 L_tg_13_bump
    s_xor_b32 s100, s32, s30
    s_and_b32 s100, s100, s101
    s_cbranch_scc0 L_tg_13_bump
    s_xor_b32 s100, s32, s31
    s_and_b32 s100, s100, s101
    s_cbranch_scc0 L_tg_13_bump
    s_and_b32 s100, s32, s101
    s_mov_b64 s[52:53], s[24:25]
    s_mov_b64 s[92:93], s[22:23]
    buffer_load_dwordx4 v[240:243], v7, s[92:95], 0 offen
    buffer_load_dwordx4 v[244:247], v7, s[92:95], 0 offen offset:128
    buffer_load_dwordx4 v[16:19], v6, s[52:55], s37 offen nt
    s_add_u32 s37, s37, s46
    buffer_load_dwordx4 v[20:23], v6, s[52:55], s37 offen nt
    s_add_u32 s37, s37, s46
    buffer_load_dwordx4 v[24:27], v6, s[52:55], s37 offen nt
    s_add_u32 s37, s37, s46
    buffer_load_dwordx4 v[28:31], v6, s[52:55], s37 offen nt
    s_add_u32 s37, s37, s46
    buffer_load_dwordx4 v[32:35], v6, s[52:55], s37 offen nt
    s_add_u32 s37, s37, s46
    buffer_load_dwordx4 v[36:39], v6, s[52:55], s37 offen nt
    s_add_u32 s37, s37, s46
    s_waitcnt vmcnt(5)
    buffer_load_dwordx4 v[40:43], v6, s[52:55], s37 offen nt
    s_add_u32 s37, s37, s46
    s_waitcnt vmcnt(5)
    buffer_load_dwordx4 v[44:47], v6, s[52:55], s37 offen nt
    s_add_u32 s37, s37, s47
    s_waitcnt vmcnt(5)
    buffer_load_dwordx4 v[48:51], v6, s[52:55], s37 offen nt
    s_add_u32 s37, s37, s46
    s_waitcnt vmcnt(5)
    buffer_load_dwordx4 v[52:55], v6, s[52:55], s37 offen nt
    s_add_u32 s37, s37, s46
    s_waitcnt vmcnt(5)
    buffer_load_dwordx4 v[56:59], v6, s[52:55], s37 offen nt
    s_add_u32 s37, s37, s46
    s_waitcnt vmcnt(5)
    buffer_load_dwordx4 v[60:63], v6, s[52:55], s37 offen nt
    s_add_u32 s37, s37, s46
    s_waitcnt vmcnt(5)
    buffer_load_dwordx4 v[64:67], v6, s[52:55], s37 offen nt
    s_add_u32 s37, s37, s46
    s_waitcnt vmcnt(5)
    buffer_load_dwordx4 v[68:71], v6, s[52:55], s37 offen nt
    s_add_u32 s37, s37, s46
    s_waitcnt vmcnt(5)
    buffer_load_dwordx4 v[72:75], v6, s[52:55], s37 offen nt
    s_add_u32 s37, s37, s46
    s_waitcnt vmcnt(5)
    buffer_load_dwordx4 v[76:79], v6, s[52:55], s37 offen nt
L_g2:
    s_sub_u32 s2, s1, 24
    s_lshr_b32 s2, s2, 1
    s_lshl_b32 s2, s2, 3
    s_add_u32 s2, s2, s0
    s_cmp_lt_u32 s2, 28
    s_cbranch_scc1 L_g_ef
    s_waitcnt vmcnt(0)
    s_branch L_g_mod
L_g_ef:
    s_and_b32 s47, s1, 1
    s_cmp_eq_u32 s47, 0
    s_cselect_b64 s[52:53], s[16:17], s[18:19]
    s_mov_b32 s54, 1835008
    s_mov_b64 s[96:97], s[20:21]
    s_mov_b32 s98, 1835008
    v_mul_u32_u24 v1, 28672, v4
    v_lshl_add_u32 v1, v5, 4, v1
    s_mul_i32 s12, s3, 458752
    s_lshl_b32 s13, s2, 7
    s_add_u32 s12, s12, s13
    s_movk_i32 s14, 3584
    s_mov_b32 s15, 204288
    s_cmp_lg_u32 s41, 0
    s_cselect_b64 vcc, -1, 0
    s_cbranch_vccnz L_th_14
    s_waitcnt vmcnt(2)
L_th_14:
    s_waitcnt vmcnt(5)
    buffer_load_dwordx4 v[144:147], v1, s[52:55], s12 offen nt
    s_add_u32 s12, s12, s14
    s_cbranch_vccnz L_th_15
    s_waitcnt vmcnt(2)
L_th_15:
    s_waitcnt vmcnt(5)
    buffer_load_dwordx4 v[148:151], v1, s[52:55], s12 offen nt
    s_add_u32 s12, s12, s14
    s_cbranch_vccnz L_th_16
    s_waitcnt vmcnt(2)
L_th_16:
    s_waitcnt vmcnt(5)
    buffer_load_dwordx4 v[152:155], v1, s[52:55], s12 offen nt
    s_add_u32 s12, s12, s14
    s_cbranch_vccnz L_th_17
    s_waitcnt vmcnt(2)
L_th_17:
    s_waitcnt vmcnt(5)
    buffer_load_dwordx4 v[156:159], v1, s[52:55], s12 offen nt
    s_add_u32 s12, s12, s14
    s_cmp_eq_u32 s41, 0
    s_cbranch_scc1 L_g_nomod
L_g_mod:
    s_mov_b32 s56, 0xff
    s_mov_b32 s57, 0xff00
    s_lshl_b32 s36, s3, 9
    v_lshl_add_u32 v11, v3, 5, s36
    v_add_u32 v11, 4096, v11
    v_lshlrev_b32 v12, 4, v3
    s_mov_b32 s59, 0xbfb8aa3b
    s_waitcnt vmcnt(20)
    v_lshlrev_b32 v112, 16, v240
    v_and_b32 v113, 0xffff0000, v240
    v_lshlrev_b32 v116, 16, v241
    v_and_b32 v117, 0xffff0000, v241
    v_lshlrev_b32 v120, 16, v242
    v_and_b32 v121, 0xffff0000, v242
    v_lshlrev_b32 v124, 16, v243
    v_and_b32 v125, 0xffff0000, v243
    v_mul_f32 v114, s59, v112
    v_mul_f32 v115, s59, v113
    v_mul_f32 v118, s59, v116
    v_mul_f32 v119, s59, v117
    v_mul_f32 v122, s59, v120
    v_mul_f32 v123, s59, v121
    v_mul_f32 v126, s59, v124
    v_mul_f32 v127, s59, v125
    v_exp_f32 v114, v114
    v_exp_f32 v115, v115
    v_exp_f32 v118, v118
    v_exp_f32 v119, v119
    v_exp_f32 v122, v122
    v_exp_f32 v123, v123
    v_exp_f32 v126, v126
    v_exp_f32 v127, v127
    v_add_f32 v114, 1.0, v114
    v_add_f32 v115, 1.0, v115
    v_add_f32 v118, 1.0, v118
    v_add_f32 v119, 1.0, v119
    v_add_f32 v122, 1.0, v122
    v_add_f32 v123, 1.0, v123
    v_add_f32 v126, 1.0, v126
    v_add_f32 v127, 1.0, v127
    v_rcp_f32 v114, v114
    v_rcp_f32 v115, v115
    v_rcp_f32 v118, v118
    v_rcp_f32 v119, v119
    v_rcp_f32 v122, v122
    v_rcp_f32 v123, v123
    v_rcp_f32 v126, v126
    v_rcp_f32 v127, v127
    v_mul_f32 v112, v112, v114
    v_mul_f32 v113, v113, v115
    v_mul_f32 v116, v116, v118
    v_mul_f32 v117, v117, v119
    v_mul_f32 v120, v120, v122
    v_mul_f32 v121, v121, v123
    v_mul_f32 v124, v124, v126
    v_mul_f32 v125, v125, v127
    v_cvt_pk_bf16_f32 v248, v112, v113
    v_cvt_pk_bf16_f32 v249, v116, v117
    v_cvt_pk_bf16_f32 v250, v120, v121
    v_cvt_pk_bf16_f32 v251, v124, v125
    v_lshlrev_b32 v112, 16, v244
    v_and_b32 v113, 0xffff0000, v244
    v_lshlrev_b32 v116, 16, v245
    v_and_b32 v117, 0xffff0000, v245
    v_lshlrev_b32 v120, 16, v246
    v_and_b32 v121, 0xffff0000, v246
    v_lshlrev_b32 v124, 16, v247
    v_and_b32 v125, 0xffff0000, v247
    v_mul_f32 v114, s59, v112
    v_mul_f32 v115, s59, v113
    v_mul_f32 v118, s59, v116
    v_mul_f32 v119, s59, v117
    v_mul_f32 v122, s59, v120
    v_mul_f32 v123, s59, v121
    v_mul_f32 v126, s59, v124
    v_mul_f32 v127, s59, v125
    v_exp_f32 v114, v114
    v_exp_f32 v115, v115
    v_exp_f32 v118, v118
    v_exp_f32 v119, v119
    v_exp_f32 v122, v122
    v_exp_f32 v123, v123
    v_exp_f32 v126, v126
    v_exp_f32 v127, v127
    v_add_f32 v114, 1.0, v114
    v_add_f32 v115, 1.0, v115
    v_add_f32 v118, 1.0, v118
    v_add_f32 v119, 1.0, v119
    v_add_f32 v122, 1.0, v122
    v_add_f32 v123, 1.0, v123
    v_add_f32 v126, 1.0, v126
    v_add_f32 v127, 1.0, v127
    v_rcp_f32 v114, v114
    v_rcp_f32 v115, v115
    v_rcp_f32 v118, v118
    v_rcp_f32 v119, v119
    v_rcp_f32 v122, v122
    v_rcp_f32 v123, v123
    v_rcp_f32 v126, v126
    v_rcp_f32 v127, v127
    v_mul_f32 v112, v112, v114
    v_mul_f32 v113, v113, v115
    v_mul_f32 v116, v116, v118
    v_mul_f32 v117, v117, v119
    v_mul_f32 v120, v120, v122
    v_mul_f32 v121, v121, v123
    v_mul_f32 v124, v124, v126
    v_mul_f32 v125, v125, v127
    v_cvt_pk_bf16_f32 v252, v112, v113
    v_cvt_pk_bf16_f32 v253, v116, v117
    v_cvt_pk_bf16_f32 v254, v120, v121
    v_cvt_pk_bf16_f32 v255, v124, v125
    s_waitcnt vmcnt(18)
    v_perm_b32 v80, v20, v16, s33
    v_perm_b32 v84, v20, v16, s34
    v_perm_b32 v88, v21, v17, s33
    v_perm_b32 v92, v21, v17, s34
    v_perm_b32 v96, v22, v18, s33
    v_perm_b32 v100, v22, v18, s34
    v_perm_b32 v104, v23, v19, s33
    v_perm_b32 v108, v23, v19, s34
    s_waitcnt vmcnt(16)
    v_perm_b32 v81, v28, v24, s33
    v_perm_b32 v85, v28, v24, s34
    v_perm_b32 v89, v29, v25, s33
    v_perm_b32 v93, v29, v25, s34
    v_perm_b32 v97, v30, v26, s33
    v_perm_b32 v101, v30, v26, s34
    v_perm_b32 v105, v31, v27, s33
    v_perm_b32 v109, v31, v27, s34
    s_waitcnt vmcnt(14)
    v_perm_b32 v82, v36, v32, s33
    v_perm_b32 v86, v36, v32, s34
    v_perm_b32 v90, v37, v33, s33
    v_perm_b32 v94, v37, v33, s34
    v_perm_b32 v98, v38, v34, s33
    v_perm_b32 v102, v38, v34, s34
    v_perm_b32 v106, v39, v35, s33
    v_perm_b32 v110, v39, v35, s34
    s_waitcnt vmcnt(12)
    v_perm_b32 v83, v44, v40, s33
    v_perm_b32 v87, v44, v40, s34
    v_perm_b32 v91, v45, v41, s33
    v_perm_b32 v95, v45, v41, s34
    v_perm_b32 v99, v46, v42, s33
    v_perm_b32 v103, v46, v42, s34
    v_perm_b32 v107, v47, v43, s33
    v_perm_b32 v111, v47, v43, s34
    v_mfma_f32_16x16x32_bf16 v[112:115], v[248:251], v[80:83], 0
    v_mfma_f32_16x16x32_bf16 v[116:119], v[248:251], v[84:87], 0
    v_mfma_f32_16x16x32_bf16 v[120:123], v[248:251], v[88:91], 0
    v_mfma_f32_16x16x32_bf16 v[124:127], v[248:251], v[92:95], 0
    v_mfma_f32_16x16x32_bf16 v[128:131], v[248:251], v[96:99], 0
    v_mfma_f32_16x16x32_bf16 v[132:135], v[248:251], v[100:103], 0
    v_mfma_f32_16x16x32_bf16 v[136:139], v[248:251], v[104:107], 0
    v_mfma_f32_16x16x32_bf16 v[140:143], v[248:251], v[108:111], 0
    s_waitcnt vmcnt(10)
    v_perm_b32 v16, v52, v48, s33
    v_perm_b32 v20, v52, v48, s34
    v_perm_b32 v24, v53, v49, s33
    v_perm_b32 v28, v53, v49, s34
    v_perm_b32 v32, v54, v50, s33
    v_perm_b32 v36, v54, v50, s34
    v_perm_b32 v40, v55, v51, s33
    v_perm_b32 v44, v55, v51, s34
    s_waitcnt vmcnt(8)
    v_perm_b32 v17, v60, v56, s33
    v_perm_b32 v21, v60, v56, s34
    v_perm_b32 v25, v61, v57, s33
    v_perm_b32 v29, v61, v57, s34
    v_perm_b32 v33, v62, v58, s33
    v_perm_b32 v37, v62, v58, s34
    v_perm_b32 v41, v63, v59, s33
    v_perm_b32 v45, v63, v59, s34
    s_waitcnt vmcnt(6)
    v_perm_b32 v18, v68, v64, s33
    v_perm_b32 v22, v68, v64, s34
    v_perm_b32 v26, v69, v65, s33
    v_perm_b32 v30, v69, v65, s34
    v_perm_b32 v34, v70, v66, s33
    v_perm_b32 v38, v70, v66, s34
    v_perm_b32 v42, v71, v67, s33
    v_perm_b32 v46, v71, v67, s34
    s_waitcnt vmcnt(4)
    v_perm_b32 v19, v76, v72, s33
    v_perm_b32 v23, v76, v72, s34
    v_perm_b32 v27, v77, v73, s33
    v_perm_b32 v31, v77, v73, s34
    v_perm_b32 v35, v78, v74, s33
    v_perm_b32 v39, v78, v74, s34
    v_perm_b32 v43, v79, v75, s33
    v_perm_b32 v47, v79, v75, s34
    v_mfma_f32_16x16x32_bf16 v[112:115], v[252:255], v[16:19], v[112:115]
    v_mfma_f32_16x16x32_bf16 v[116:119], v[252:255], v[20:23], v[116:119]
    v_mfma_f32_16x16x32_bf16 v[120:123], v[252:255], v[24:27], v[120:123]
    v_mfma_f32_16x16x32_bf16 v[124:127], v[252:255], v[28:31], v[124:127]
    v_mfma_f32_16x16x32_bf16 v[128:131], v[252:255], v[32:35], v[128:131]
    v_mfma_f32_16x16x32_bf16 v[132:135], v[252:255], v[36:39], v[132:135]
    v_mfma_f32_16x16x32_bf16 v[136:139], v[252:255], v[40:43], v[136:139]
    v_mfma_f32_16x16x32_bf16 v[140:143], v[252:255], v[44:47], v[140:143]
    s_mov_b64 exec, s[56:57]
    s_nop 0
    ds_write2_b32 v11, v112, v116 offset0:0 offset1:1
    s_nop 0
    ds_write2_b32 v11, v120, v124 offset0:2 offset1:3
    s_nop 0
    ds_write2_b32 v11, v128, v132 offset0:4 offset1:5
    s_nop 0
    ds_write2_b32 v11, v136, v140 offset0:6 offset1:7
    s_mov_b64 exec, -1
    v_mov_b32 v82, 0
    v_mov_b32 v83, s32
    s_waitcnt lgkmcnt(0)
    s_barrier
    ds_read_b128 v[48:51], v12 offset:4096
    ds_read_b128 v[52:55], v12 offset:4352
    ds_read_b128 v[56:59], v12 offset:4608
    ds_read_b128 v[60:63], v12 offset:4864
    ds_read_b128 v[64:67], v12 offset:5120
    ds_read_b128 v[68:71], v12 offset:5376
    ds_read_b128 v[72:75], v12 offset:5632
    ds_read_b128 v[76:79], v12 offset:5888
    s_waitcnt lgkmcnt(6)
    v_pk_add_f32 v[48:49], v[48:49], v[52:53]
    v_pk_add_f32 v[50:51], v[50:51], v[54:55]
    s_waitcnt lgkmcnt(4)
    v_pk_add_f32 v[56:57], v[56:57], v[60:61]
    v_pk_add_f32 v[58:59], v[58:59], v[62:63]
    s_waitcnt lgkmcnt(2)
    v_pk_add_f32 v[64:65], v[64:65], v[68:69]
    v_pk_add_f32 v[66:67], v[66:67], v[70:71]
    s_waitcnt lgkmcnt(0)
    v_pk_add_f32 v[72:73], v[72:73], v[76:77]
    v_pk_add_f32 v[74:75], v[74:75], v[78:79]
    v_pk_add_f32 v[48:49], v[48:49], v[56:57]
    v_pk_add_f32 v[50:51], v[50:51], v[58:59]
    v_pk_add_f32 v[64:65], v[64:65], v[72:73]
    v_pk_add_f32 v[66:67], v[66:67], v[74:75]
    v_pk_add_f32 v[48:49], v[48:49], v[64:65]
    v_pk_add_f32 v[50:51], v[50:51], v[66:67]
    v_cvt_pk_bf16_f32 v80, v48, v49
    v_cvt_pk_bf16_f32 v81, v50, v51
    s_cmp_lg_u32 s3, 0
    s_cbranch_scc1 L_g_nost0
    s_mov_b64 exec, 0xffff
    buffer_store_dwordx4 v[80:83], v8, s[48:51], s41 offen sc1
    s_mov_b64 exec, -1
L_g_nost0:
    s_cmp_ge_u32 s2, 28
    s_cbranch_scc1 L_end
L_g_nomod:
    s_cbranch_vccnz L_th_18
    s_waitcnt vmcnt(2)
L_th_18:
    s_waitcnt vmcnt(5)
    buffer_load_dwordx4 v[160:163], v1, s[52:55], s12 offen nt
    s_add_u32 s12, s12, s14
    s_cbranch_vccnz L_th_19
    s_waitcnt vmcnt(2)
L_th_19:
    s_waitcnt vmcnt(5)
    buffer_load_dwordx4 v[164:167], v1, s[52:55], s12 offen nt
    s_add_u32 s12, s12, s14
    s_cbranch_vccnz L_th_20
    s_waitcnt vmcnt(2)
L_th_20:
    s_waitcnt vmcnt(5)
    buffer_load_dwordx4 v[168:171], v1, s[52:55], s12 offen nt
    s_add_u32 s12, s12, s14
    s_cbranch_vccnz L_th_21
    s_waitcnt vmcnt(2)
L_th_21:
    s_waitcnt vmcnt(5)
    buffer_load_dwordx4 v[172:175], v1, s[52:55], s12 offen nt
    s_add_u32 s12, s12, s15
    s_cbranch_vccnz L_th_22
    s_waitcnt vmcnt(2)
L_th_22:
    s_waitcnt vmcnt(5)
    buffer_load_dwordx4 v[176:179], v1, s[52:55], s12 offen nt
    s_add_u32 s12, s12, s14
    s_cbranch_vccnz L_th_23
    s_waitcnt vmcnt(2)
L_th_23:
    s_waitcnt vmcnt(5)
    buffer_load_dwordx4 v[180:183], v1, s[52:55], s12 offen nt
    s_add_u32 s12, s12, s14
    s_cbranch_vccnz L_th_24
    s_waitcnt vmcnt(2)
L_th_24:
    s_waitcnt vmcnt(5)
    buffer_load_dwordx4 v[184:187], v1, s[52:55], s12 offen nt
    s_add_u32 s12, s12, s14
    s_cbranch_vccnz L_th_25
    s_waitcnt vmcnt(2)
L_th_25:
    s_waitcnt vmcnt(5)
    buffer_load_dwordx4 v[188:191], v1, s[52:55], s12 offen nt
    s_add_u32 s12, s12, s14
    s_cbranch_vccnz L_th_26
    s_waitcnt vmcnt(2)
L_th_26:
    s_waitcnt vmcnt(5)
    buffer_load_dwordx4 v[192:195], v1, s[52:55], s12 offen nt
    s_add_u32 s12, s12, s14
    s_cbranch_vccnz L_th_27
    s_waitcnt vmcnt(2)
L_th_27:
    s_waitcnt vmcnt(5)
    buffer_load_dwordx4 v[196:199], v1, s[52:55], s12 offen nt
    s_add_u32 s12, s12, s14
    s_cbranch_vccnz L_th_28
    s_waitcnt vmcnt(2)
L_th_28:
    s_waitcnt vmcnt(5)
    buffer_load_dwordx4 v[200:203], v1, s[52:55], s12 offen nt
    s_add_u32 s12, s12, s14
    s_cbranch_vccnz L_th_29
    s_waitcnt vmcnt(2)
L_th_29:
    s_waitcnt vmcnt(5)
    buffer_load_dwordx4 v[204:207], v1, s[52:55], s12 offen nt
    s_mov_b32 s56, 0xff
    s_mov_b32 s57, 0xff00
    s_lshl_b32 s40, s0, 7
    s_add_u32 s40, s40, 98304
    v_mov_b32 v6, 0
    s_mov_b64 s[92:93], s[4:5]
    s_lshl_b32 s43, s2, 1
    s_add_u32 s43, s43, s47
    s_lshl_b32 s43, s43, 8
    s_add_u32 s43, s43, 106496
    s_add_u32 s42, s43, 2097152
    v_lshlrev_b32 v13, 2, v0
    v_and_b32 v9, 31, v0
    v_lshrrev_b32 v5, 5, v0
    v_lshl_add_u32 v12, v9, 1, v5
    v_lshlrev_b32 v9, 4, v9
    v_lshl_add_u32 v10, v12, 2, s39
    v_lshl_add_u32 v11, v4, 4, s39
    v_lshrrev_b32 v4, 3, v10
    v_lshlrev_b32 v4, 4, v4
    s_lshl_b32 s36, s3, 9
    v_lshl_add_u32 v12, v3, 5, s36
    v_lshl_add_u32 v9, v5, 11, v9
    s_mov_b32 s37, 4096
    s_mov_b32 s38, 8192
    s_lshl_b32 s45, s0, 15
    s_add_u32 s36, s36, s45
    s_add_u32 s36, s36, 1179648
    s_add_u32 s45, s36, 4096
    s_add_u32 s46, s36, 16384
    s_add_u32 s41, s36, 20480
    s_mov_b32 s12, 0
    s_mov_b32 s13, -1
    buffer_load_dword v254, v10, s[92:95], 0 offen
    buffer_load_dwordx4 v[112:115], v4, s[48:51], s37 offen sc1
    buffer_load_dwordx4 v[116:119], v4, s[48:51], s37 offen offset:2048 sc1
    buffer_load_dwordx4 v[120:123], v4, s[48:51], s38 offen sc1
    buffer_load_dwordx2 v[124:125], v6, s[48:51], s40 offen sc1
    s_waitcnt vmcnt(19)
    v_perm_b32 v16, v148, v144, s33
    v_perm_b32 v20, v148, v144, s34
    v_perm_b32 v24, v149, v145, s33
    v_perm_b32 v28, v149, v145, s34
    v_perm_b32 v32, v150, v146, s33
    v_perm_b32 v36, v150, v146, s34
    v_perm_b32 v40, v151, v147, s33
    v_perm_b32 v44, v151, v147, s34
    s_waitcnt vmcnt(17)
    v_perm_b32 v17, v156, v152, s33
    v_perm_b32 v21, v156, v152, s34
    v_perm_b32 v25, v157, v153, s33
    v_perm_b32 v29, v157, v153, s34
    v_perm_b32 v33, v158, v154, s33
    v_perm_b32 v37, v158, v154, s34
    v_perm_b32 v41, v159, v155, s33
    v_perm_b32 v45, v159, v155, s34
    s_waitcnt vmcnt(15)
    v_perm_b32 v18, v164, v160, s33
    v_perm_b32 v22, v164, v160, s34
    v_perm_b32 v26, v165, v161, s33
    v_perm_b32 v30, v165, v161, s34
    v_perm_b32 v34, v166, v162, s33
    v_perm_b32 v38, v166, v162, s34
    v_perm_b32 v42, v167, v163, s33
    v_perm_b32 v46, v167, v163, s34
    s_waitcnt vmcnt(13)
    v_perm_b32 v19, v172, v168, s33
    v_perm_b32 v23, v172, v168, s34
    v_perm_b32 v27, v173, v169, s33
    v_perm_b32 v31, v173, v169, s34
    v_perm_b32 v35, v174, v170, s33
    v_perm_b32 v39, v174, v170, s34
    v_perm_b32 v43, v175, v171, s33
    v_perm_b32 v47, v175, v171, s34
    s_waitcnt vmcnt(11)
    v_perm_b32 v48, v180, v176, s33
    v_perm_b32 v52, v180, v176, s34
    v_perm_b32 v56, v181, v177, s33
    v_perm_b32 v60, v181, v177, s34
    v_perm_b32 v64, v182, v178, s33
    v_perm_b32 v68, v182, v178, s34
    v_perm_b32 v72, v183, v179, s33
    v_perm_b32 v76, v183, v179, s34
    s_waitcnt vmcnt(9)
    v_perm_b32 v49, v188, v184, s33
    v_perm_b32 v53, v188, v184, s34
    v_perm_b32 v57, v189, v185, s33
    v_perm_b32 v61, v189, v185, s34
    v_perm_b32 v65, v190, v186, s33
    v_perm_b32 v69, v190, v186, s34
    v_perm_b32 v73, v191, v187, s33
    v_perm_b32 v77, v191, v187, s34
    s_waitcnt vmcnt(7)
    v_perm_b32 v50, v196, v192, s33
    v_perm_b32 v54, v196, v192, s34
    v_perm_b32 v58, v197, v193, s33
    v_perm_b32 v62, v197, v193, s34
    v_perm_b32 v66, v198, v194, s33
    v_perm_b32 v70, v198, v194, s34
    v_perm_b32 v74, v199, v195, s33
    v_perm_b32 v78, v199, v195, s34
    s_waitcnt vmcnt(5)
    v_perm_b32 v51, v204, v200, s33
    v_perm_b32 v55, v204, v200, s34
    v_perm_b32 v59, v205, v201, s33
    v_perm_b32 v63, v205, v201, s34
    v_perm_b32 v67, v206, v202, s33
    v_perm_b32 v71, v206, v202, s34
    v_perm_b32 v75, v207, v203, s33
    v_perm_b32 v79, v207, v203, s34
    s_mov_b32 s35, 0
    s_branch L_ps_30_back
L_ps_30:
    buffer_load_dwordx4 v[112:115], v4, s[48:51], s37 offen sc1
    buffer_load_dwordx4 v[116:119], v4, s[48:51], s37 offen offset:2048 sc1
    buffer_load_dwordx4 v[120:123], v4, s[48:51], s38 offen sc1
    buffer_load_dwordx2 v[124:125], v6, s[48:51], s40 offen sc1
    s_add_u32 s35, s35, 1
    s_cmp_ge_u32 s35, 256
    s_cbranch_scc1 L_ps_30_rare
L_ps_30_back:
    s_waitcnt vmcnt(0)
    v_bitop3_b32 v15, v115, v119, s32 bitop3:0x7e
    v_bitop3_b32 v15, v15, v123, s32 bitop3:0xf6
    v_bitop3_b32 v15, v15, v125, s32 bitop3:0xf6
    v_cmp_ne_u32 vcc, 0, v15
    s_cbranch_vccnz L_ps_30
    v_add_u32 v9, v9, v124
    buffer_load_dwordx4 v[192:195], v9, s[48:51], s36 offen sc1
    buffer_load_dwordx4 v[196:199], v9, s[48:51], s45 offen sc1
    buffer_load_dwordx4 v[200:203], v9, s[48:51], s46 offen sc1
    buffer_load_dwordx4 v[204:207], v9, s[48:51], s41 offen sc1
    v_cndmask_b32 v14, v112, v113, s[12:13]
    v_lshlrev_b32 v244, 16, v14
    v_and_b32 v245, 0xffff0000, v14
    v_cndmask_b32 v14, v116, v117, s[12:13]
    v_lshlrev_b32 v240, 16, v14
    v_and_b32 v241, 0xffff0000, v14
    v_cndmask_b32 v14, v120, v121, s[12:13]
    v_lshlrev_b32 v242, 16, v14
    v_and_b32 v243, 0xffff0000, v14
    v_add_f32 v242, 1.0, v242
    v_add_f32 v243, 1.0, v243
    v_cvt_pk_bf16_f32 v242, 0, v242
    v_cvt_pk_bf16_f32 v243, 0, v243
    v_lshlrev_b32 v246, 16, v254
    v_and_b32 v247, 0xffff0000, v254
    s_lshl_b32 s40, s3, 4
    v_mov_b32 v255, s40
    v_and_b32 v254, 3, v0
    v_lshlrev_b32 v254, 4, v254
    s_mov_b32 s38, 0
    s_brev_b32 s39, 1
    s_mov_b32 s59, 0x43000000
    v_mov_b32 v239, s32
    s_mov_b32 s35, 0
    s_branch L_px_31_back
L_px_31:
    buffer_load_dwordx4 v[192:195], v9, s[48:51], s36 offen sc1
    buffer_load_dwordx4 v[196:199], v9, s[48:51], s45 offen sc1
    buffer_load_dwordx4 v[200:203], v9, s[48:51], s46 offen sc1
    buffer_load_dwordx4 v[204:207], v9, s[48:51], s41 offen sc1
    s_add_u32 s35, s35, 1
    s_cmp_ge_u32 s35, 256
    s_cbranch_scc1 L_px_31_rare
L_px_31_back:
    s_waitcnt vmcnt(0)
    v_xor_b32 v193, s100, v193
    v_xor_b32 v195, s100, v195
    v_xor_b32 v197, s100, v197
    v_xor_b32 v199, s100, v199
    v_xor_b32 v201, s100, v201
    v_xor_b32 v203, s100, v203
    v_xor_b32 v205, s100, v205
    v_xor_b32 v207, s100, v207
    v_or_b32 v15, v193, v195
    v_or3_b32 v15, v15, v197, v199
    v_or3_b32 v15, v15, v201, v203
    v_or3_b32 v15, v15, v205, v207
    v_and_b32 v15, 0xff, v15
    v_cmp_ne_u32 vcc, 0, v15
    s_cbranch_vccnz L_px_31
    v_pk_add_f32 v[144:145], v[192:193], v[196:197]
    v_pk_add_f32 v[146:147], v[194:195], v[198:199]
    v_pk_add_f32 v[148:149], v[200:201], v[204:205]
    v_pk_add_f32 v[150:151], v[202:203], v[206:207]
    v_pk_add_f32 v[144:145], v[144:145], v[148:149]
    v_pk_add_f32 v[146:147], v[146:147], v[150:151]
    s_nop 1
    v_permlane32_swap_b32 v144, v146
    v_permlane32_swap_b32 v145, v147
    v_pk_add_f32 v[248:249], v[144:145], v[146:147]
    v_cvt_pk_bf16_f32 v248, 0, v248
    v_cvt_pk_bf16_f32 v249, 0, v249
    v_pk_mul_f32 v[248:249], v[248:249], v[244:245]
    v_cvt_pk_bf16_f32 v248, 0, v248
    v_cvt_pk_bf16_f32 v249, 0, v249
    v_pk_add_f32 v[248:249], v[248:249], v[246:247]
    v_cvt_pk_bf16_f32 v248, 0, v248
    v_cvt_pk_bf16_f32 v249, 0, v249
    v_readlane_b32 s37, v248, 63
    v_mov_b32 v250, v248
    s_nop 0
    v_subrev_f32 v244, s37, v248
    v_subrev_f32 v245, s37, v249
    v_add_f32 v251, v244, v245
    v_mul_f32 v252, v244, v244
    v_fmac_f32 v252, v245, v245
    v_add_f32_dpp v251, v251, v251 row_ror:8 row_mask:0xf bank_mask:0xf
    s_nop 0
    v_add_f32_dpp v252, v252, v252 row_ror:8 row_mask:0xf bank_mask:0xf
    v_add_f32_dpp v251, v251, v251 row_ror:4 row_mask:0xf bank_mask:0xf
    s_nop 0
    v_add_f32_dpp v252, v252, v252 row_ror:4 row_mask:0xf bank_mask:0xf
    v_add_f32_dpp v251, v251, v251 row_ror:2 row_mask:0xf bank_mask:0xf
    s_nop 0
    v_add_f32_dpp v252, v252, v252 row_ror:2 row_mask:0xf bank_mask:0xf
    v_add_f32_dpp v251, v251, v251 row_ror:1 row_mask:0xf bank_mask:0xf
    s_nop 0
    v_add_f32_dpp v252, v252, v252 row_ror:1 row_mask:0xf bank_mask:0xf
    v_add_f32_dpp v251, v251, v251 row_bcast:15 row_mask:0xa bank_mask:0xf
    s_nop 0
    v_add_f32_dpp v252, v252, v252 row_bcast:15 row_mask:0xa bank_mask:0xf
    v_add_f32_dpp v251, v251, v251 row_bcast:31 row_mask:0xc bank_mask:0xf
    s_nop 0
    v_add_f32_dpp v252, v252, v252 row_bcast:31 row_mask:0xc bank_mask:0xf
    s_mov_b64 exec, s[38:39]
    ds_write_b96 v255, v[250:252] offset:10240
    s_mov_b64 exec, -1
    s_waitcnt lgkmcnt(0)
    s_barrier
    ds_read_b96 v[250:252], v254 offset:10240
    s_waitcnt lgkmcnt(0)
    v_fma_f32 v244, v250, s59, v251
    s_nop 1
    v_add_f32_dpp v244, v244, v244 quad_perm:[1,0,3,2] row_mask:0xf bank_mask:0xf
    s_nop 1
    v_add_f32_dpp v244, v244, v244 quad_perm:[2,3,0,1] row_mask:0xf bank_mask:0xf
    v_mul_f32 v244, 0x3b000000, v244
    v_sub_f32 v245, v244, v250
    v_cvt_pk_bf16_f32 v250, 0, v244
    v_mul_f32 v253, s59, v245
    v_fma_f32 v253, v251, -2.0, v253
    v_fmac_f32 v252, v245, v253
    v_sub_f32 v248, v248, v250
    v_sub_f32 v249, v249, v250
    v_add_f32_dpp v252, v252, v252 quad_perm:[1,0,3,2] row_mask:0xf bank_mask:0xf
    v_cvt_pk_bf16_f32 v248, 0, v248
    v_cvt_pk_bf16_f32 v249, 0, v249
    v_add_f32_dpp v252, v252, v252 quad_perm:[2,3,0,1] row_mask:0xf bank_mask:0xf
    v_mul_f32 v252, 0x3b000000, v252
    v_max_f32 v252, 0, v252
    v_cvt_pk_bf16_f32 v252, 0, v252
    v_add_f32 v252, 0x3727c5ac, v252
    v_cvt_pk_bf16_f32 v252, 0, v252
    v_sqrt_f32 v252, v252
    s_nop 0
    v_cvt_pk_bf16_f32 v252, 0, v252
    v_rcp_f32 v251, v252
    s_nop 0
    v_mul_f32 v248, v248, v251
    v_mul_f32 v249, v249, v251
    v_cvt_pk_bf16_f32 v248, 0, v248
    v_cvt_pk_bf16_f32 v249, 0, v249
    v_pk_mul_f32 v[248:249], v[248:249], v[242:243]
    v_cvt_pk_bf16_f32 v248, 0, v248
    v_cvt_pk_bf16_f32 v249, 0, v249
    v_pk_add_f32 v[248:249], v[248:249], v[240:241]
    v_cvt_pk_bf16_f32 v14, v248, v249
    ds_write_b32 v10, v14 offset:8192
    ds_read_b128 v[244:247], v11 offset:8192
    ds_read_b128 v[248:251], v11 offset:8320
    s_waitcnt lgkmcnt(1)
    v_mfma_f32_16x16x32_bf16 v[112:115], v[244:247], v[16:19], 0
    v_mfma_f32_16x16x32_bf16 v[116:119], v[244:247], v[20:23], 0
    v_mfma_f32_16x16x32_bf16 v[120:123], v[244:247], v[24:27], 0
    v_mfma_f32_16x16x32_bf16 v[124:127], v[244:247], v[28:31], 0
    v_mfma_f32_16x16x32_bf16 v[128:131], v[244:247], v[32:35], 0
    v_mfma_f32_16x16x32_bf16 v[132:135], v[244:247], v[36:39], 0
    v_mfma_f32_16x16x32_bf16 v[136:139], v[244:247], v[40:43], 0
    v_mfma_f32_16x16x32_bf16 v[140:143], v[244:247], v[44:47], 0
    s_waitcnt lgkmcnt(0)
    v_mfma_f32_16x16x32_bf16 v[112:115], v[248:251], v[48:51], v[112:115]
    v_mfma_f32_16x16x32_bf16 v[116:119], v[248:251], v[52:55], v[116:119]
    v_mfma_f32_16x16x32_bf16 v[120:123], v[248:251], v[56:59], v[120:123]
    v_mfma_f32_16x16x32_bf16 v[124:127], v[248:251], v[60:63], v[124:127]
    v_mfma_f32_16x16x32_bf16 v[128:131], v[248:251], v[64:67], v[128:131]
    v_mfma_f32_16x16x32_bf16 v[132:135], v[248:251], v[68:71], v[132:135]
    v_mfma_f32_16x16x32_bf16 v[136:139], v[248:251], v[72:75], v[136:139]
    v_mfma_f32_16x16x32_bf16 v[140:143], v[248:251], v[76:79], v[140:143]
    s_mov_b64 exec, s[56:57]
    s_nop 0
    ds_write2_b32 v12, v112, v116 offset0:0 offset1:1
    s_nop 0
    ds_write2_b32 v12, v120, v124 offset0:2 offset1:3
    s_nop 0
    ds_write2_b32 v12, v128, v132 offset0:4 offset1:5
    s_nop 0
    ds_write2_b32 v12, v136, v140 offset0:6 offset1:7
    s_mov_b64 exec, -1
    s_waitcnt lgkmcnt(0)
    s_barrier
    s_cmp_lg_u32 s3, 3
    s_cbranch_scc1 L_end
    ds_read2st64_b32 v[144:145], v13 offset0:0 offset1:1
    ds_read2st64_b32 v[146:147], v13 offset0:2 offset1:3
    ds_read2st64_b32 v[148:149], v13 offset0:4 offset1:5
    ds_read2st64_b32 v[150:151], v13 offset0:6 offset1:7
    s_waitcnt lgkmcnt(2)
    v_pk_add_f32 v[144:145], v[144:145], v[146:147]
    s_waitcnt lgkmcnt(0)
    v_pk_add_f32 v[148:149], v[148:149], v[150:151]
    v_pk_add_f32 v[144:145], v[144:145], v[148:149]
    v_add_f32 v144, v144, v145
    v_cvt_pk_bf16_f32 v144, 0, v144
    v_bfi_b32 v146, s101, v239, v144
    buffer_store_dword v146, v13, s[48:51], s43 offen
    s_waitcnt vmcnt(0)
    buffer_store_dword v146, v13, s[48:51], s42 offen sc1
    s_branch L_end
    .p2align 6
L_f:
    s_sub_u32 s47, s1, 4
    s_lshr_b32 s2, s47, 1
    s_lshl_b32 s2, s2, 3
    s_add_u32 s2, s2, s0
    s_cmp_ge_u32 s2, 28
    s_cbranch_scc1 L_end
    s_and_b32 s47, s47, 1
    s_mov_b64 s[96:97], s[20:21]
    s_mov_b32 s98, 1835008
    v_lshlrev_b32 v7, 13, v2
    v_lshl_add_u32 v7, v3, 4, v7
    s_lshl_b32 s59, s2, 16
    s_lshr_b32 s14, s3, 1
    s_lshl_b32 s38, s14, 15
    s_add_u32 s59, s59, s38
    s_lshl_b32 s38, s47, 1
    s_and_b32 s40, s3, 1
    s_add_u32 s38, s38, s40
    s_lshl_b32 s40, s38, 8
    s_add_u32 s59, s59, s40
    s_lshl_b32 s58, s2, 1
    s_add_u32 s58, s58, s14
    s_lshr_b32 s40, s58, 2
    s_lshl_b32 s40, s40, 14
    s_and_b32 s58, s58, 3
    s_lshl_b32 s58, s58, 11
    s_add_u32 s58, s58, s40
    s_lshl_b32 s38, s38, 9
    s_add_u32 s58, s58, s38
    s_add_u32 s58, s58, 1441792
    s_add_u32 s15, s58, 8192
    s_lshl_b32 s44, s2, 9
    s_add_u32 s44, s44, 106496
    v_lshlrev_b32 v13, 2, v0
    v_lshlrev_b32 v6, 3, v0
    s_lshl_b32 s40, s3, 7
    v_lshl_add_u32 v9, v0, 1, s40
    s_lshl_b32 s41, s14, 6
    s_add_u32 s40, s40, s41
    v_lshl_add_u32 v5, v2, 4, s40
    v_mov_b32 v139, s32
    v_mov_b32 v138, 0x3d372713
    buffer_load_dwordx4 v[16:19], v7, s[96:99], s59 offen offset:0 nt
    buffer_load_dwordx4 v[20:23], v7, s[96:99], s59 offen offset:1024 nt
    buffer_load_dwordx4 v[24:27], v7, s[96:99], s59 offen offset:2048 nt
    buffer_load_dwordx4 v[28:31], v7, s[96:99], s59 offen offset:3072 nt
    s_addk_i32 s59, 4096
    buffer_load_dwordx4 v[32:35], v7, s[96:99], s59 offen offset:0 nt
    buffer_load_dwordx4 v[36:39], v7, s[96:99], s59 offen offset:1024 nt
    buffer_load_dwordx4 v[40:43], v7, s[96:99], s59 offen offset:2048 nt
    buffer_load_dwordx4 v[44:47], v7, s[96:99], s59 offen offset:3072 nt
    s_waitcnt vmcnt(6)
    v_perm_b32 v48, v20, v16, s33
    v_perm_b32 v52, v20, v16, s34
    v_perm_b32 v56, v21, v17, s33
    v_perm_b32 v60, v21, v17, s34
    v_perm_b32 v64, v22, v18, s33
    v_perm_b32 v68, v22, v18, s34
    v_perm_b32 v72, v23, v19, s33
    v_perm_b32 v76, v23, v19, s34
    s_waitcnt vmcnt(4)
    v_perm_b32 v49, v28, v24, s33
    v_perm_b32 v53, v28, v24, s34
    v_perm_b32 v57, v29, v25, s33
    v_perm_b32 v61, v29, v25, s34
    v_perm_b32 v65, v30, v26, s33
    v_perm_b32 v69, v30, v26, s34
    v_perm_b32 v73, v31, v27, s33
    v_perm_b32 v77, v31, v27, s34
    s_waitcnt vmcnt(2)
    v_perm_b32 v50, v36, v32, s33
    v_perm_b32 v54, v36, v32, s34
    v_perm_b32 v58, v37, v33, s33
    v_perm_b32 v62, v37, v33, s34
    v_perm_b32 v66, v38, v34, s33
    v_perm_b32 v70, v38, v34, s34
    v_perm_b32 v74, v39, v35, s33
    v_perm_b32 v78, v39, v35, s34
    s_waitcnt vmcnt(0)
    v_perm_b32 v51, v44, v40, s33
    v_perm_b32 v55, v44, v40, s34
    v_perm_b32 v59, v45, v41, s33
    v_perm_b32 v63, v45, v41, s34
    v_perm_b32 v67, v46, v42, s33
    v_perm_b32 v71, v46, v42, s34
    v_perm_b32 v75, v47, v43, s33
    v_perm_b32 v79, v47, v43, s34
    s_mov_b32 s35, 0
    buffer_load_dword v130, v13, s[48:51], s44 offen sc1
    buffer_load_dword v131, v13, s[48:51], s44 offen offset:256 sc1
L_pe_32:
    buffer_load_dword v130, v13, s[48:51], s44 offen sc1
    buffer_load_dword v131, v13, s[48:51], s44 offen offset:256 sc1
    s_add_u32 s35, s35, 1
    s_cmp_ge_u32 s35, 256
    s_cbranch_scc1 L_pe_32_rare
L_pe_32_back:
    s_waitcnt vmcnt(2)
    v_xor_b32 v132, s100, v130
    v_xor_b32 v133, s100, v131
    v_or_b32 v15, v132, v133
    v_and_b32 v15, 0xff, v15
    v_cmp_ne_u32 vcc, 0, v15
    s_cbranch_vccnz L_pe_32
    v_mul_f32 v134, v132, v132
    v_fma_f32 v134, v134, v138, 1.0
    v_mul_f32 v134, v134, v132
    v_mul_f32 v134, 0xc0135761, v134
    v_exp_f32 v134, v134
    s_nop 0
    v_add_f32 v134, 1.0, v134
    v_rcp_f32 v134, v134
    s_nop 0
    v_mul_f32 v132, v132, v134
    v_cvt_pk_bf16_f32 v132, 0, v132
    v_mul_f32 v132, v132, v133
    v_cvt_pk_bf16_f32 v134, v132, v132
    ds_write_b16 v9, v134 offset:9216
    ds_read_b128 v[140:143], v5 offset:9216
    s_waitcnt lgkmcnt(0)
    v_mfma_f32_16x16x32_bf16 v[80:83], v[140:143], v[48:51], 0
    v_mfma_f32_16x16x32_bf16 v[84:87], v[140:143], v[52:55], 0
    v_mfma_f32_16x16x32_bf16 v[88:91], v[140:143], v[56:59], 0
    v_mfma_f32_16x16x32_bf16 v[92:95], v[140:143], v[60:63], 0
    v_mfma_f32_16x16x32_bf16 v[96:99], v[140:143], v[64:67], 0
    v_mfma_f32_16x16x32_bf16 v[100:103], v[140:143], v[68:71], 0
    v_mfma_f32_16x16x32_bf16 v[104:107], v[140:143], v[72:75], 0
    v_mfma_f32_16x16x32_bf16 v[108:111], v[140:143], v[76:79], 0
    s_nop 0
    v_mov_b32_dpp v136, v80 quad_perm:[0,1,2,3] row_mask:1 bank_mask:0xf
    v_mov_b32_dpp v137, v84 quad_perm:[0,1,2,3] row_mask:1 bank_mask:0xf
    s_nop 0
    v_mov_b32_dpp v136, v88 quad_perm:[0,1,2,3] row_mask:2 bank_mask:0xf
    v_mov_b32_dpp v137, v92 quad_perm:[0,1,2,3] row_mask:2 bank_mask:0xf
    s_nop 0
    v_mov_b32_dpp v136, v96 quad_perm:[0,1,2,3] row_mask:4 bank_mask:0xf
    v_mov_b32_dpp v137, v100 quad_perm:[0,1,2,3] row_mask:4 bank_mask:0xf
    s_nop 0
    v_mov_b32_dpp v136, v104 quad_perm:[0,1,2,3] row_mask:8 bank_mask:0xf
    v_mov_b32_dpp v137, v108 quad_perm:[0,1,2,3] row_mask:8 bank_mask:0xf
    v_bfi_b32 v137, s101, v139, v137
    buffer_store_dwordx2 v[136:137], v6, s[48:51], s58 offen sc1
    buffer_store_dwordx2 v[136:137], v6, s[48:51], s15 offen sc1
L_end:
L_exit:
    s_endpgm
L_tg_1_bump:
    s_add_u32 s32, s32, 1
    s_branch L_tg_1
L_tg_2_bump:
    s_add_u32 s32, s32, 1
    s_branch L_tg_2
L_tg_3_bump:
    s_add_u32 s32, s32, 1
    s_branch L_tg_3
L_ph_4_rare:
    s_cmp_gt_u32 s35, 400000
    s_cbranch_scc1 L_end
    s_branch L_ph_4_back
L_psx_5_rare:
    s_cmp_gt_u32 s35, 400000
    s_cbranch_scc1 L_end
    s_cmp_lg_u32 s35, 256
    s_cbranch_scc1 L_psx_5_back
    s_waitcnt vmcnt(0)
    s_add_u32 s43, s43, 2097152
    v_not_b32 v241, s32
    s_branch L_psx_5_back
L_pp_6_rare:
    s_cmp_gt_u32 s35, 400000
    s_cbranch_scc1 L_end
    s_cmp_lg_u32 s35, 256
    s_cbranch_scc1 L_pp_6_back
    s_waitcnt vmcnt(0)
    s_add_u32 s46, s46, 2097152
    s_add_u32 s47, s47, 2097152
    v_not_b32 v17, s32
    s_branch L_pp_6_back
L_tg_7_bump:
    s_add_u32 s32, s32, 1
    s_branch L_tg_7
L_pq_8_rare:
    s_cmp_gt_u32 s35, 400000
    s_cbranch_scc1 L_kbail
    s_cmp_lg_u32 s35, 256
    s_cbranch_scc1 L_pq_8_back
    s_waitcnt vmcnt(0)
    s_add_u32 s46, s46, 2097152
    v_not_b32 v123, s32
    s_branch L_pq_8_back
L_pg_9_rare:
    s_cmp_gt_u32 s35, 400000
    s_cbranch_scc1 L_end
    s_branch L_pg_9_back
L_pxs_10_rare:
    s_cmp_gt_u32 s35, 400000
    s_cbranch_scc1 L_end
    s_branch L_pxs_10_back
L_py_11_rare:
    s_cmp_gt_u32 s35, 400000
    s_cbranch_scc1 L_end
    s_branch L_py_11_back
L_tg_12_bump:
    s_add_u32 s32, s32, 1
    s_branch L_tg_12
L_tg_13_bump:
    s_add_u32 s32, s32, 1
    s_branch L_tg_13
L_ps_30_rare:
    s_cmp_gt_u32 s35, 400000
    s_cbranch_scc1 L_end
    s_branch L_ps_30_back
L_px_31_rare:
    s_cmp_gt_u32 s35, 400000
    s_cbranch_scc1 L_end
    s_branch L_px_31_back
L_pe_32_rare:
    s_cmp_gt_u32 s35, 400000
    s_cbranch_scc1 L_end
    s_cmp_lg_u32 s35, 256
    s_cbranch_scc1 L_pe_32_back
    s_waitcnt vmcnt(0)
    s_add_u32 s44, s44, 2097152
    v_not_b32 v130, s32
    s_branch L_pe_32_back
L_codeend:
s_endpgm
.section .rodata,"a"
.p2align 6
.amdhsa_kernel adaLN_cond__sliding_block_cached__geglu_ffn__decode_kernel
  .amdhsa_next_free_vgpr 256
  .amdhsa_next_free_sgpr 102
  .amdhsa_accum_offset 256
  .amdhsa_group_segment_fixed_size 0
  .amdhsa_kernarg_size 112
  .amdhsa_user_sgpr_count 2
  .amdhsa_user_sgpr_kernarg_segment_ptr 1
  .amdhsa_system_sgpr_workgroup_id_x 1
.end_amdhsa_kernel
```
